```python
import torch

def _softmax(x, axis=-1):
    return torch.softmax(x, dim=axis)
def _gelu(x):
    return torch.nn.functional.gelu(x, approximate="tanh")
def _silu(x):
    return torch.nn.functional.silu(x)
def _sigmoid(x):
    return torch.sigmoid(x)
def _layernorm(x, axis=-1, eps=1e-5):
    m = x.mean(dim=axis, keepdim=True)
    v = x.var(dim=axis, keepdim=True, unbiased=False)
    return (x - m) / torch.sqrt(v + eps)
def _scatter_add(tgt, idx, src, axis=0):
    return tgt.clone().index_add_(axis, idx, src)
def _segment_sum(src, seg, n):
    out = torch.zeros((n,) + src.shape[1:], dtype=src.dtype)
    return out.index_add_(0, seg, src)
def _pad(x, pw):
    flat = tuple(v for pair in reversed(pw) for v in pair)
    return torch.nn.functional.pad(x, flat)

kernel_name = 'concat_heads__compressed_kv_cla__mha_block_cached__decode'

def setup_inputs():

    _w = (lambda a: (lambda t: t.to(torch.bfloat16) if t.is_floating_point() else t)(torch.as_tensor(a)))
    def _A_setup():
        B, H, Sq, Sk, D, M = 2, 32, 1, 8192, 128, 512
        Dc = 4 * D
        return {
            "x": _w((lambda *s: torch.randn(*s, dtype=torch.bfloat16) * 3.2)(B, Sq, M)),
            "c_kv": _w((lambda *s: torch.randn(*s, dtype=torch.bfloat16) * 0.1)(B, Sk, Dc)),
            "w_q": _w((lambda *s: torch.randn(*s, dtype=torch.bfloat16) * 6.4)(M, H, D) * (M ** -0.5)),
            "w_uk": _w((lambda *s: torch.randn(*s, dtype=torch.bfloat16) * 6.4)(Dc, H, D) * (Dc ** -0.5)),
            "w_uv": _w((lambda *s: torch.randn(*s, dtype=torch.bfloat16) * 0.1)(Dc, H, D) * (Dc ** -0.5)),
            "w_o": _w((lambda *s: torch.randn(*s, dtype=torch.bfloat16) * 0.1)(H, D, M) * ((H * D) ** -0.5)),
        }
    _A_in = _A_setup()

    def _B_setup():
        B, Sq, D = 2, 1, 512
        H, Sk, Dh = 32, 8192, 128
        return {
            "x": _w((lambda *s: torch.randn(*s, dtype=torch.bfloat16) * 1.6)(B, Sq, D)),
            "k_cache": _w((lambda *s: torch.randn(*s, dtype=torch.bfloat16) * 1.6)(B, H, Sk, Dh)),
            "v_cache": _w((lambda *s: torch.randn(*s, dtype=torch.bfloat16) * 0.05)(B, H, Sk, Dh)),
            "wq": _w((lambda *s: torch.randn(*s, dtype=torch.bfloat16) * 1.6)(D, H * Dh) * (D ** -0.5)),
            "wo": _w((lambda *s: torch.randn(*s, dtype=torch.bfloat16) * 0.05)(H * Dh, D) * ((H * Dh) ** -0.5)),
        }
    _B_in = _B_setup()

    return {
        "A_x": _A_in["x"],
        "A_c_kv": _A_in["c_kv"],
        "A_w_q": _A_in["w_q"],
        "A_w_uk": _A_in["w_uk"],
        "A_w_uv": _A_in["w_uv"],
        "A_w_o": _A_in["w_o"],
        "B_x": _B_in["x"],
        "B_k_cache": _B_in["k_cache"],
        "B_v_cache": _B_in["v_cache"],
        "B_wq": _B_in["wq"],
        "B_wo": _B_in["wo"],
    }

def reference(A_x, A_c_kv, A_w_q, A_w_uk, A_w_uv, A_w_o, B_x, B_k_cache, B_v_cache, B_wq, B_wo):
    def _A_ref(x, c_kv, w_q, w_uk, w_uv, w_o):
        B, Sq, M = x.shape[0], x.shape[1], x.shape[2]
        Sk = c_kv.shape[1]
        H, D = w_q.shape[1], w_q.shape[2]
        q = torch.einsum("bqm,mhd->bhqd", x, w_q)
        k = torch.einsum("bkc,chd->bhkd", c_kv, w_uk)
        v = torch.einsum("bkc,chd->bhkd", c_kv, w_uv)
        scores = torch.einsum("bhqd,bhkd->bhqk", q, k) * (D ** -0.5)
        off = Sk - Sq
        qi = torch.arange(Sq)[:, None]
        kj = torch.arange(Sk)[None, :]
        cmask = kj <= (qi + off)
        scores = torch.where(cmask[None, None], scores, -1e9)
        p = _softmax(scores, axis=-1)
        ctx = torch.einsum("bhqk,bhkd->bhqd", p, v)
        return torch.einsum("bhqd,hdm->bqm", ctx, w_o)

    def _B_ref(x, k_cache, v_cache, wq, wo):
        B, Sq, D = x.shape
        H, Dh = 32, 128
        q = (lambda x, *d: x.permute(*d))((x @ wq).reshape(B, Sq, H, Dh), 0, 2, 1, 3)
        scores = torch.einsum("bhqd,bhkd->bhqk", q, k_cache) * (Dh ** -0.5)
        p = _softmax(scores, axis=-1)
        o = torch.einsum("bhqk,bhkd->bhqd", p, v_cache)
        return (lambda x, *d: x.permute(*d))(o, 0, 2, 1, 3).reshape(B, Sq, H * Dh) @ wo

    a = _A_ref(A_x, A_c_kv, A_w_q, A_w_uk, A_w_uv, A_w_o)
    b = _B_ref(B_x, B_k_cache, B_v_cache, B_wq, B_wo)
    return torch.concatenate([a, b], axis=-1)
```

```asm
; @launch grid=(256,1,1) block=(512,1,1) lds=161792
.amdgcn_target "amdgcn-amd-amdhsa--gfx950"
.text
.globl concat_heads__compressed_kv_cla__mha_block_cached__decode_kernel
.p2align 8
.type concat_heads__compressed_kv_cla__mha_block_cached__decode_kernel,@function
concat_heads__compressed_kv_cla__mha_block_cached__decode_kernel:
  s_cmp_ge_u32 s2, 256
  s_cbranch_scc1 L_end
  s_load_dwordx16 s[16:31], s[0:1], 0
  s_load_dwordx8 s[32:39], s[0:1], 64
  s_load_dwordx4 s[40:43], s[0:1], 96
  v_lshrrev_b32 v1, 6, v0
  s_mov_b32 s80, 0x3fb8aa3b
  s_mov_b32 s81, 0x3db504f3
  s_mov_b32 s82, 0x3e0293ee
  v_readfirstlane_b32 s48, v1
  v_and_b32 v1, 63, v0
  v_lshrrev_b32 v2, 4, v1
  v_and_b32 v3, 15, v1
  v_mov_b32 v4, 0
  s_and_b32 s3, s2, 7
  s_lshl_b32 s3, s3, 2
  s_cmp_ge_u32 s2, 64
  s_cbranch_scc1 L_bwg
  s_lshr_b32 s4, s2, 3
  s_and_b32 s45, s4, 1
  s_lshr_b32 s4, s4, 1
  s_add_u32 s44, s3, s4
  s_lshr_b32 s49, s2, 5
  s_and_b32 s50, s2, 31
  v_lshrrev_b32 v5, 3, v1
  v_and_b32 v6, 7, v1
  s_waitcnt lgkmcnt(0)
  s_lshl_b32 s3, s49, 23
  s_lshl_b32 s4, s50, 18
  s_add_u32 s3, s3, s4
  s_add_u32 s60, s18, s3
  s_addc_u32 s61, s19, 0
  s_and_b32 s61, s61, 0xffff
  s_mov_b32 s62, 0x40000
  s_mov_b32 s63, 0x20000
  v_lshlrev_b32 v7, 16, v5
  v_lshl_add_u32 v7, v6, 4, v7
  v_lshlrev_b32 v8, 4, v5
  v_lshlrev_b32 v9, 17, v2
  v_lshl_add_u32 v9, v3, 4, v9
  v_lshlrev_b32 v10, 5, v2
  v_lshlrev_b32 v11, 13, v3
  v_lshl_add_u32 v11, v2, 4, v11
  v_lshlrev_b32 v20, 4, v1
  s_lshl_b32 s64, s44, 8
  s_lshl_b32 s65, s48, 19
  s_add_u32 s64, s64, s65
  s_lshl_b32 s65, s45, 7
  s_add_u32 s65, s64, s65
  s_lshl_b32 s66, s48, 7
  s_add_u32 s86, s16, s66
  s_addc_u32 s87, s17, 0
  global_load_dwordx4 v[64:67], v10, s[86:87] offset:0
  global_load_dwordx4 v[68:71], v10, s[86:87] offset:16
  global_load_dwordx4 v[72:75], v10, s[86:87] offset:1024
  global_load_dwordx4 v[76:79], v10, s[86:87] offset:1040
  s_add_u32 s88, s20, s64
  s_addc_u32 s89, s21, 0
  global_load_dwordx4 v[80:83], v9, s[88:89] nt
  s_add_u32 s88, s88, 8192
  s_addc_u32 s89, s89, 0
  global_load_dwordx4 v[84:87], v9, s[88:89] nt
  s_add_u32 s88, s88, 8192
  s_addc_u32 s89, s89, 0
  global_load_dwordx4 v[88:91], v9, s[88:89] nt
  s_add_u32 s88, s88, 8192
  s_addc_u32 s89, s89, 0
  global_load_dwordx4 v[92:95], v9, s[88:89] nt
  s_add_u32 s88, s88, 8192
  s_addc_u32 s89, s89, 0
  global_load_dwordx4 v[96:99], v9, s[88:89] nt
  s_add_u32 s88, s88, 8192
  s_addc_u32 s89, s89, 0
  global_load_dwordx4 v[100:103], v9, s[88:89] nt
  s_add_u32 s88, s88, 8192
  s_addc_u32 s89, s89, 0
  global_load_dwordx4 v[104:107], v9, s[88:89] nt
  s_add_u32 s88, s88, 8192
  s_addc_u32 s89, s89, 0
  global_load_dwordx4 v[108:111], v9, s[88:89] nt
  s_add_u32 s88, s88, 8192
  s_addc_u32 s89, s89, 0
  global_load_dwordx4 v[112:115], v9, s[88:89] nt
  s_add_u32 s88, s88, 8192
  s_addc_u32 s89, s89, 0
  global_load_dwordx4 v[116:119], v9, s[88:89] nt
  s_add_u32 s88, s88, 8192
  s_addc_u32 s89, s89, 0
  global_load_dwordx4 v[120:123], v9, s[88:89] nt
  s_add_u32 s88, s88, 8192
  s_addc_u32 s89, s89, 0
  global_load_dwordx4 v[124:127], v9, s[88:89] nt
  s_add_u32 s88, s88, 8192
  s_addc_u32 s89, s89, 0
  global_load_dwordx4 v[128:131], v9, s[88:89] nt
  s_add_u32 s88, s88, 8192
  s_addc_u32 s89, s89, 0
  global_load_dwordx4 v[132:135], v9, s[88:89] nt
  s_add_u32 s88, s88, 8192
  s_addc_u32 s89, s89, 0
  global_load_dwordx4 v[136:139], v9, s[88:89] nt
  s_add_u32 s88, s88, 8192
  s_addc_u32 s89, s89, 0
  global_load_dwordx4 v[140:143], v9, s[88:89] nt
  s_lshl_b32 s67, s44, 8
  s_lshl_b32 s68, s45, 21
  s_add_u32 s67, s67, s68
  s_lshl_b32 s68, s48, 18
  s_add_u32 s67, s67, s68
  s_add_u32 s88, s22, s67
  s_addc_u32 s89, s23, 0
  global_load_dwordx4 v[144:147], v11, s[88:89] offset:0 nt
  global_load_dwordx4 v[148:151], v11, s[88:89] offset:64 nt
  global_load_dwordx4 v[152:155], v11, s[88:89] offset:128 nt
  global_load_dwordx4 v[156:159], v11, s[88:89] offset:192 nt
  s_add_u32 s88, s88, 131072
  s_addc_u32 s89, s89, 0
  global_load_dwordx4 v[160:163], v11, s[88:89] offset:0 nt
  global_load_dwordx4 v[164:167], v11, s[88:89] offset:64 nt
  global_load_dwordx4 v[168:171], v11, s[88:89] offset:128 nt
  global_load_dwordx4 v[172:175], v11, s[88:89] offset:192 nt
  s_cmp_eq_u32 s48, 0
  s_cbranch_scc0 L_w0_1
  s_lshl_b32 s67, s2, 7
  s_add_u32 s90, s42, s67
  s_addc_u32 s91, s43, 0
  s_add_u32 s90, s90, 983040
  s_addc_u32 s91, s91, 0
  s_add_u32 s92, s42, s67
  s_addc_u32 s93, s43, 0
  s_add_u32 s92, s92, 999424
  s_addc_u32 s93, s93, 0
  s_mov_b64 exec, 1
  global_store_dword v4, v4, s[90:91] sc1
  global_store_dword v4, v4, s[92:93] sc1
  s_mov_b64 exec, -1
L_w0_1:
  v_mov_b32 v240, 0
  v_mov_b32 v241, 0
  v_mov_b32 v242, 0
  v_mov_b32 v243, 0
  v_mov_b32 v244, 0
  v_mov_b32 v245, 0
  v_mov_b32 v246, 0
  v_mov_b32 v247, 0
  v_mov_b32 v248, 0
  v_mov_b32 v249, 0
  v_mov_b32 v250, 0
  v_mov_b32 v251, 0
  v_mov_b32 v252, 0
  v_mov_b32 v253, 0
  v_mov_b32 v254, 0
  v_mov_b32 v255, 0
  s_waitcnt vmcnt(8)
  v_lshlrev_b32 v14, 16, v64
  v_lshlrev_b32 v15, 16, v72
  v_lshlrev_b32 v12, 16, v80
  v_and_b32 v13, 0xffff0000, v80
  v_fmac_f32 v240, v14, v12
  v_fmac_f32 v241, v14, v13
  v_fmac_f32 v248, v15, v12
  v_fmac_f32 v249, v15, v13
  v_lshlrev_b32 v12, 16, v81
  v_and_b32 v13, 0xffff0000, v81
  v_fmac_f32 v242, v14, v12
  v_fmac_f32 v243, v14, v13
  v_fmac_f32 v250, v15, v12
  v_fmac_f32 v251, v15, v13
  v_lshlrev_b32 v12, 16, v82
  v_and_b32 v13, 0xffff0000, v82
  v_fmac_f32 v244, v14, v12
  v_fmac_f32 v245, v14, v13
  v_fmac_f32 v252, v15, v12
  v_fmac_f32 v253, v15, v13
  v_lshlrev_b32 v12, 16, v83
  v_and_b32 v13, 0xffff0000, v83
  v_fmac_f32 v246, v14, v12
  v_fmac_f32 v247, v14, v13
  v_fmac_f32 v254, v15, v12
  v_fmac_f32 v255, v15, v13
  v_and_b32 v14, 0xffff0000, v64
  v_and_b32 v15, 0xffff0000, v72
  v_lshlrev_b32 v12, 16, v84
  v_and_b32 v13, 0xffff0000, v84
  v_fmac_f32 v240, v14, v12
  v_fmac_f32 v241, v14, v13
  v_fmac_f32 v248, v15, v12
  v_fmac_f32 v249, v15, v13
  v_lshlrev_b32 v12, 16, v85
  v_and_b32 v13, 0xffff0000, v85
  v_fmac_f32 v242, v14, v12
  v_fmac_f32 v243, v14, v13
  v_fmac_f32 v250, v15, v12
  v_fmac_f32 v251, v15, v13
  v_lshlrev_b32 v12, 16, v86
  v_and_b32 v13, 0xffff0000, v86
  v_fmac_f32 v244, v14, v12
  v_fmac_f32 v245, v14, v13
  v_fmac_f32 v252, v15, v12
  v_fmac_f32 v253, v15, v13
  v_lshlrev_b32 v12, 16, v87
  v_and_b32 v13, 0xffff0000, v87
  v_fmac_f32 v246, v14, v12
  v_fmac_f32 v247, v14, v13
  v_fmac_f32 v254, v15, v12
  v_fmac_f32 v255, v15, v13
  v_lshlrev_b32 v14, 16, v65
  v_lshlrev_b32 v15, 16, v73
  v_lshlrev_b32 v12, 16, v88
  v_and_b32 v13, 0xffff0000, v88
  v_fmac_f32 v240, v14, v12
  v_fmac_f32 v241, v14, v13
  v_fmac_f32 v248, v15, v12
  v_fmac_f32 v249, v15, v13
  v_lshlrev_b32 v12, 16, v89
  v_and_b32 v13, 0xffff0000, v89
  v_fmac_f32 v242, v14, v12
  v_fmac_f32 v243, v14, v13
  v_fmac_f32 v250, v15, v12
  v_fmac_f32 v251, v15, v13
  v_lshlrev_b32 v12, 16, v90
  v_and_b32 v13, 0xffff0000, v90
  v_fmac_f32 v244, v14, v12
  v_fmac_f32 v245, v14, v13
  v_fmac_f32 v252, v15, v12
  v_fmac_f32 v253, v15, v13
  v_lshlrev_b32 v12, 16, v91
  v_and_b32 v13, 0xffff0000, v91
  v_fmac_f32 v246, v14, v12
  v_fmac_f32 v247, v14, v13
  v_fmac_f32 v254, v15, v12
  v_fmac_f32 v255, v15, v13
  v_and_b32 v14, 0xffff0000, v65
  v_and_b32 v15, 0xffff0000, v73
  v_lshlrev_b32 v12, 16, v92
  v_and_b32 v13, 0xffff0000, v92
  v_fmac_f32 v240, v14, v12
  v_fmac_f32 v241, v14, v13
  v_fmac_f32 v248, v15, v12
  v_fmac_f32 v249, v15, v13
  v_lshlrev_b32 v12, 16, v93
  v_and_b32 v13, 0xffff0000, v93
  v_fmac_f32 v242, v14, v12
  v_fmac_f32 v243, v14, v13
  v_fmac_f32 v250, v15, v12
  v_fmac_f32 v251, v15, v13
  v_lshlrev_b32 v12, 16, v94
  v_and_b32 v13, 0xffff0000, v94
  v_fmac_f32 v244, v14, v12
  v_fmac_f32 v245, v14, v13
  v_fmac_f32 v252, v15, v12
  v_fmac_f32 v253, v15, v13
  v_lshlrev_b32 v12, 16, v95
  v_and_b32 v13, 0xffff0000, v95
  v_fmac_f32 v246, v14, v12
  v_fmac_f32 v247, v14, v13
  v_fmac_f32 v254, v15, v12
  v_fmac_f32 v255, v15, v13
  v_lshlrev_b32 v14, 16, v66
  v_lshlrev_b32 v15, 16, v74
  v_lshlrev_b32 v12, 16, v96
  v_and_b32 v13, 0xffff0000, v96
  v_fmac_f32 v240, v14, v12
  v_fmac_f32 v241, v14, v13
  v_fmac_f32 v248, v15, v12
  v_fmac_f32 v249, v15, v13
  v_lshlrev_b32 v12, 16, v97
  v_and_b32 v13, 0xffff0000, v97
  v_fmac_f32 v242, v14, v12
  v_fmac_f32 v243, v14, v13
  v_fmac_f32 v250, v15, v12
  v_fmac_f32 v251, v15, v13
  v_lshlrev_b32 v12, 16, v98
  v_and_b32 v13, 0xffff0000, v98
  v_fmac_f32 v244, v14, v12
  v_fmac_f32 v245, v14, v13
  v_fmac_f32 v252, v15, v12
  v_fmac_f32 v253, v15, v13
  v_lshlrev_b32 v12, 16, v99
  v_and_b32 v13, 0xffff0000, v99
  v_fmac_f32 v246, v14, v12
  v_fmac_f32 v247, v14, v13
  v_fmac_f32 v254, v15, v12
  v_fmac_f32 v255, v15, v13
  v_and_b32 v14, 0xffff0000, v66
  v_and_b32 v15, 0xffff0000, v74
  v_lshlrev_b32 v12, 16, v100
  v_and_b32 v13, 0xffff0000, v100
  v_fmac_f32 v240, v14, v12
  v_fmac_f32 v241, v14, v13
  v_fmac_f32 v248, v15, v12
  v_fmac_f32 v249, v15, v13
  v_lshlrev_b32 v12, 16, v101
  v_and_b32 v13, 0xffff0000, v101
  v_fmac_f32 v242, v14, v12
  v_fmac_f32 v243, v14, v13
  v_fmac_f32 v250, v15, v12
  v_fmac_f32 v251, v15, v13
  v_lshlrev_b32 v12, 16, v102
  v_and_b32 v13, 0xffff0000, v102
  v_fmac_f32 v244, v14, v12
  v_fmac_f32 v245, v14, v13
  v_fmac_f32 v252, v15, v12
  v_fmac_f32 v253, v15, v13
  v_lshlrev_b32 v12, 16, v103
  v_and_b32 v13, 0xffff0000, v103
  v_fmac_f32 v246, v14, v12
  v_fmac_f32 v247, v14, v13
  v_fmac_f32 v254, v15, v12
  v_fmac_f32 v255, v15, v13
  v_lshlrev_b32 v14, 16, v67
  v_lshlrev_b32 v15, 16, v75
  v_lshlrev_b32 v12, 16, v104
  v_and_b32 v13, 0xffff0000, v104
  v_fmac_f32 v240, v14, v12
  v_fmac_f32 v241, v14, v13
  v_fmac_f32 v248, v15, v12
  v_fmac_f32 v249, v15, v13
  v_lshlrev_b32 v12, 16, v105
  v_and_b32 v13, 0xffff0000, v105
  v_fmac_f32 v242, v14, v12
  v_fmac_f32 v243, v14, v13
  v_fmac_f32 v250, v15, v12
  v_fmac_f32 v251, v15, v13
  v_lshlrev_b32 v12, 16, v106
  v_and_b32 v13, 0xffff0000, v106
  v_fmac_f32 v244, v14, v12
  v_fmac_f32 v245, v14, v13
  v_fmac_f32 v252, v15, v12
  v_fmac_f32 v253, v15, v13
  v_lshlrev_b32 v12, 16, v107
  v_and_b32 v13, 0xffff0000, v107
  v_fmac_f32 v246, v14, v12
  v_fmac_f32 v247, v14, v13
  v_fmac_f32 v254, v15, v12
  v_fmac_f32 v255, v15, v13
  v_and_b32 v14, 0xffff0000, v67
  v_and_b32 v15, 0xffff0000, v75
  v_lshlrev_b32 v12, 16, v108
  v_and_b32 v13, 0xffff0000, v108
  v_fmac_f32 v240, v14, v12
  v_fmac_f32 v241, v14, v13
  v_fmac_f32 v248, v15, v12
  v_fmac_f32 v249, v15, v13
  v_lshlrev_b32 v12, 16, v109
  v_and_b32 v13, 0xffff0000, v109
  v_fmac_f32 v242, v14, v12
  v_fmac_f32 v243, v14, v13
  v_fmac_f32 v250, v15, v12
  v_fmac_f32 v251, v15, v13
  v_lshlrev_b32 v12, 16, v110
  v_and_b32 v13, 0xffff0000, v110
  v_fmac_f32 v244, v14, v12
  v_fmac_f32 v245, v14, v13
  v_fmac_f32 v252, v15, v12
  v_fmac_f32 v253, v15, v13
  v_lshlrev_b32 v12, 16, v111
  v_and_b32 v13, 0xffff0000, v111
  v_fmac_f32 v246, v14, v12
  v_fmac_f32 v247, v14, v13
  v_fmac_f32 v254, v15, v12
  v_fmac_f32 v255, v15, v13
  v_lshlrev_b32 v14, 16, v68
  v_lshlrev_b32 v15, 16, v76
  v_lshlrev_b32 v12, 16, v112
  v_and_b32 v13, 0xffff0000, v112
  v_fmac_f32 v240, v14, v12
  v_fmac_f32 v241, v14, v13
  v_fmac_f32 v248, v15, v12
  v_fmac_f32 v249, v15, v13
  v_lshlrev_b32 v12, 16, v113
  v_and_b32 v13, 0xffff0000, v113
  v_fmac_f32 v242, v14, v12
  v_fmac_f32 v243, v14, v13
  v_fmac_f32 v250, v15, v12
  v_fmac_f32 v251, v15, v13
  v_lshlrev_b32 v12, 16, v114
  v_and_b32 v13, 0xffff0000, v114
  v_fmac_f32 v244, v14, v12
  v_fmac_f32 v245, v14, v13
  v_fmac_f32 v252, v15, v12
  v_fmac_f32 v253, v15, v13
  v_lshlrev_b32 v12, 16, v115
  v_and_b32 v13, 0xffff0000, v115
  v_fmac_f32 v246, v14, v12
  v_fmac_f32 v247, v14, v13
  v_fmac_f32 v254, v15, v12
  v_fmac_f32 v255, v15, v13
  v_and_b32 v14, 0xffff0000, v68
  v_and_b32 v15, 0xffff0000, v76
  v_lshlrev_b32 v12, 16, v116
  v_and_b32 v13, 0xffff0000, v116
  v_fmac_f32 v240, v14, v12
  v_fmac_f32 v241, v14, v13
  v_fmac_f32 v248, v15, v12
  v_fmac_f32 v249, v15, v13
  v_lshlrev_b32 v12, 16, v117
  v_and_b32 v13, 0xffff0000, v117
  v_fmac_f32 v242, v14, v12
  v_fmac_f32 v243, v14, v13
  v_fmac_f32 v250, v15, v12
  v_fmac_f32 v251, v15, v13
  v_lshlrev_b32 v12, 16, v118
  v_and_b32 v13, 0xffff0000, v118
  v_fmac_f32 v244, v14, v12
  v_fmac_f32 v245, v14, v13
  v_fmac_f32 v252, v15, v12
  v_fmac_f32 v253, v15, v13
  v_lshlrev_b32 v12, 16, v119
  v_and_b32 v13, 0xffff0000, v119
  v_fmac_f32 v246, v14, v12
  v_fmac_f32 v247, v14, v13
  v_fmac_f32 v254, v15, v12
  v_fmac_f32 v255, v15, v13
  v_lshlrev_b32 v14, 16, v69
  v_lshlrev_b32 v15, 16, v77
  v_lshlrev_b32 v12, 16, v120
  v_and_b32 v13, 0xffff0000, v120
  v_fmac_f32 v240, v14, v12
  v_fmac_f32 v241, v14, v13
  v_fmac_f32 v248, v15, v12
  v_fmac_f32 v249, v15, v13
  v_lshlrev_b32 v12, 16, v121
  v_and_b32 v13, 0xffff0000, v121
  v_fmac_f32 v242, v14, v12
  v_fmac_f32 v243, v14, v13
  v_fmac_f32 v250, v15, v12
  v_fmac_f32 v251, v15, v13
  v_lshlrev_b32 v12, 16, v122
  v_and_b32 v13, 0xffff0000, v122
  v_fmac_f32 v244, v14, v12
  v_fmac_f32 v245, v14, v13
  v_fmac_f32 v252, v15, v12
  v_fmac_f32 v253, v15, v13
  v_lshlrev_b32 v12, 16, v123
  v_and_b32 v13, 0xffff0000, v123
  v_fmac_f32 v246, v14, v12
  v_fmac_f32 v247, v14, v13
  v_fmac_f32 v254, v15, v12
  v_fmac_f32 v255, v15, v13
  v_and_b32 v14, 0xffff0000, v69
  v_and_b32 v15, 0xffff0000, v77
  v_lshlrev_b32 v12, 16, v124
  v_and_b32 v13, 0xffff0000, v124
  v_fmac_f32 v240, v14, v12
  v_fmac_f32 v241, v14, v13
  v_fmac_f32 v248, v15, v12
  v_fmac_f32 v249, v15, v13
  v_lshlrev_b32 v12, 16, v125
  v_and_b32 v13, 0xffff0000, v125
  v_fmac_f32 v242, v14, v12
  v_fmac_f32 v243, v14, v13
  v_fmac_f32 v250, v15, v12
  v_fmac_f32 v251, v15, v13
  v_lshlrev_b32 v12, 16, v126
  v_and_b32 v13, 0xffff0000, v126
  v_fmac_f32 v244, v14, v12
  v_fmac_f32 v245, v14, v13
  v_fmac_f32 v252, v15, v12
  v_fmac_f32 v253, v15, v13
  v_lshlrev_b32 v12, 16, v127
  v_and_b32 v13, 0xffff0000, v127
  v_fmac_f32 v246, v14, v12
  v_fmac_f32 v247, v14, v13
  v_fmac_f32 v254, v15, v12
  v_fmac_f32 v255, v15, v13
  v_lshlrev_b32 v14, 16, v70
  v_lshlrev_b32 v15, 16, v78
  v_lshlrev_b32 v12, 16, v128
  v_and_b32 v13, 0xffff0000, v128
  v_fmac_f32 v240, v14, v12
  v_fmac_f32 v241, v14, v13
  v_fmac_f32 v248, v15, v12
  v_fmac_f32 v249, v15, v13
  v_lshlrev_b32 v12, 16, v129
  v_and_b32 v13, 0xffff0000, v129
  v_fmac_f32 v242, v14, v12
  v_fmac_f32 v243, v14, v13
  v_fmac_f32 v250, v15, v12
  v_fmac_f32 v251, v15, v13
  v_lshlrev_b32 v12, 16, v130
  v_and_b32 v13, 0xffff0000, v130
  v_fmac_f32 v244, v14, v12
  v_fmac_f32 v245, v14, v13
  v_fmac_f32 v252, v15, v12
  v_fmac_f32 v253, v15, v13
  v_lshlrev_b32 v12, 16, v131
  v_and_b32 v13, 0xffff0000, v131
  v_fmac_f32 v246, v14, v12
  v_fmac_f32 v247, v14, v13
  v_fmac_f32 v254, v15, v12
  v_fmac_f32 v255, v15, v13
  v_and_b32 v14, 0xffff0000, v70
  v_and_b32 v15, 0xffff0000, v78
  v_lshlrev_b32 v12, 16, v132
  v_and_b32 v13, 0xffff0000, v132
  v_fmac_f32 v240, v14, v12
  v_fmac_f32 v241, v14, v13
  v_fmac_f32 v248, v15, v12
  v_fmac_f32 v249, v15, v13
  v_lshlrev_b32 v12, 16, v133
  v_and_b32 v13, 0xffff0000, v133
  v_fmac_f32 v242, v14, v12
  v_fmac_f32 v243, v14, v13
  v_fmac_f32 v250, v15, v12
  v_fmac_f32 v251, v15, v13
  v_lshlrev_b32 v12, 16, v134
  v_and_b32 v13, 0xffff0000, v134
  v_fmac_f32 v244, v14, v12
  v_fmac_f32 v245, v14, v13
  v_fmac_f32 v252, v15, v12
  v_fmac_f32 v253, v15, v13
  v_lshlrev_b32 v12, 16, v135
  v_and_b32 v13, 0xffff0000, v135
  v_fmac_f32 v246, v14, v12
  v_fmac_f32 v247, v14, v13
  v_fmac_f32 v254, v15, v12
  v_fmac_f32 v255, v15, v13
  v_lshlrev_b32 v14, 16, v71
  v_lshlrev_b32 v15, 16, v79
  v_lshlrev_b32 v12, 16, v136
  v_and_b32 v13, 0xffff0000, v136
  v_fmac_f32 v240, v14, v12
  v_fmac_f32 v241, v14, v13
  v_fmac_f32 v248, v15, v12
  v_fmac_f32 v249, v15, v13
  v_lshlrev_b32 v12, 16, v137
  v_and_b32 v13, 0xffff0000, v137
  v_fmac_f32 v242, v14, v12
  v_fmac_f32 v243, v14, v13
  v_fmac_f32 v250, v15, v12
  v_fmac_f32 v251, v15, v13
  v_lshlrev_b32 v12, 16, v138
  v_and_b32 v13, 0xffff0000, v138
  v_fmac_f32 v244, v14, v12
  v_fmac_f32 v245, v14, v13
  v_fmac_f32 v252, v15, v12
  v_fmac_f32 v253, v15, v13
  v_lshlrev_b32 v12, 16, v139
  v_and_b32 v13, 0xffff0000, v139
  v_fmac_f32 v246, v14, v12
  v_fmac_f32 v247, v14, v13
  v_fmac_f32 v254, v15, v12
  v_fmac_f32 v255, v15, v13
  v_and_b32 v14, 0xffff0000, v71
  v_and_b32 v15, 0xffff0000, v79
  v_lshlrev_b32 v12, 16, v140
  v_and_b32 v13, 0xffff0000, v140
  v_fmac_f32 v240, v14, v12
  v_fmac_f32 v241, v14, v13
  v_fmac_f32 v248, v15, v12
  v_fmac_f32 v249, v15, v13
  v_lshlrev_b32 v12, 16, v141
  v_and_b32 v13, 0xffff0000, v141
  v_fmac_f32 v242, v14, v12
  v_fmac_f32 v243, v14, v13
  v_fmac_f32 v250, v15, v12
  v_fmac_f32 v251, v15, v13
  v_lshlrev_b32 v12, 16, v142
  v_and_b32 v13, 0xffff0000, v142
  v_fmac_f32 v244, v14, v12
  v_fmac_f32 v245, v14, v13
  v_fmac_f32 v252, v15, v12
  v_fmac_f32 v253, v15, v13
  v_lshlrev_b32 v12, 16, v143
  v_and_b32 v13, 0xffff0000, v143
  v_fmac_f32 v246, v14, v12
  v_fmac_f32 v247, v14, v13
  v_fmac_f32 v254, v15, v12
  v_fmac_f32 v255, v15, v13
  ds_swizzle_b32 v176, v240 offset:0x401f
  ds_swizzle_b32 v177, v241 offset:0x401f
  ds_swizzle_b32 v178, v242 offset:0x401f
  ds_swizzle_b32 v179, v243 offset:0x401f
  ds_swizzle_b32 v180, v244 offset:0x401f
  ds_swizzle_b32 v181, v245 offset:0x401f
  ds_swizzle_b32 v182, v246 offset:0x401f
  ds_swizzle_b32 v183, v247 offset:0x401f
  ds_swizzle_b32 v184, v248 offset:0x401f
  ds_swizzle_b32 v185, v249 offset:0x401f
  ds_swizzle_b32 v186, v250 offset:0x401f
  ds_swizzle_b32 v187, v251 offset:0x401f
  ds_swizzle_b32 v188, v252 offset:0x401f
  ds_swizzle_b32 v189, v253 offset:0x401f
  ds_swizzle_b32 v190, v254 offset:0x401f
  ds_swizzle_b32 v191, v255 offset:0x401f
  s_waitcnt lgkmcnt(0)
  v_add_f32 v240, v240, v176
  v_add_f32 v241, v241, v177
  v_add_f32 v242, v242, v178
  v_add_f32 v243, v243, v179
  v_add_f32 v244, v244, v180
  v_add_f32 v245, v245, v181
  v_add_f32 v246, v246, v182
  v_add_f32 v247, v247, v183
  v_add_f32 v248, v248, v184
  v_add_f32 v249, v249, v185
  v_add_f32 v250, v250, v186
  v_add_f32 v251, v251, v187
  v_add_f32 v252, v252, v188
  v_add_f32 v253, v253, v189
  v_add_f32 v254, v254, v190
  v_add_f32 v255, v255, v191
  v_mov_b32 v12, v240
  v_mov_b32 v13, v240
  s_nop 1
  v_permlane32_swap_b32 v12, v13
  s_nop 1
  v_add_f32 v240, v12, v13
  v_mov_b32 v12, v241
  v_mov_b32 v13, v241
  s_nop 1
  v_permlane32_swap_b32 v12, v13
  s_nop 1
  v_add_f32 v241, v12, v13
  v_mov_b32 v12, v242
  v_mov_b32 v13, v242
  s_nop 1
  v_permlane32_swap_b32 v12, v13
  s_nop 1
  v_add_f32 v242, v12, v13
  v_mov_b32 v12, v243
  v_mov_b32 v13, v243
  s_nop 1
  v_permlane32_swap_b32 v12, v13
  s_nop 1
  v_add_f32 v243, v12, v13
  v_mov_b32 v12, v244
  v_mov_b32 v13, v244
  s_nop 1
  v_permlane32_swap_b32 v12, v13
  s_nop 1
  v_add_f32 v244, v12, v13
  v_mov_b32 v12, v245
  v_mov_b32 v13, v245
  s_nop 1
  v_permlane32_swap_b32 v12, v13
  s_nop 1
  v_add_f32 v245, v12, v13
  v_mov_b32 v12, v246
  v_mov_b32 v13, v246
  s_nop 1
  v_permlane32_swap_b32 v12, v13
  s_nop 1
  v_add_f32 v246, v12, v13
  v_mov_b32 v12, v247
  v_mov_b32 v13, v247
  s_nop 1
  v_permlane32_swap_b32 v12, v13
  s_nop 1
  v_add_f32 v247, v12, v13
  v_mov_b32 v12, v248
  v_mov_b32 v13, v248
  s_nop 1
  v_permlane32_swap_b32 v12, v13
  s_nop 1
  v_add_f32 v248, v12, v13
  v_mov_b32 v12, v249
  v_mov_b32 v13, v249
  s_nop 1
  v_permlane32_swap_b32 v12, v13
  s_nop 1
  v_add_f32 v249, v12, v13
  v_mov_b32 v12, v250
  v_mov_b32 v13, v250
  s_nop 1
  v_permlane32_swap_b32 v12, v13
  s_nop 1
  v_add_f32 v250, v12, v13
  v_mov_b32 v12, v251
  v_mov_b32 v13, v251
  s_nop 1
  v_permlane32_swap_b32 v12, v13
  s_nop 1
  v_add_f32 v251, v12, v13
  v_mov_b32 v12, v252
  v_mov_b32 v13, v252
  s_nop 1
  v_permlane32_swap_b32 v12, v13
  s_nop 1
  v_add_f32 v252, v12, v13
  v_mov_b32 v12, v253
  v_mov_b32 v13, v253
  s_nop 1
  v_permlane32_swap_b32 v12, v13
  s_nop 1
  v_add_f32 v253, v12, v13
  v_mov_b32 v12, v254
  v_mov_b32 v13, v254
  s_nop 1
  v_permlane32_swap_b32 v12, v13
  s_nop 1
  v_add_f32 v254, v12, v13
  v_mov_b32 v12, v255
  v_mov_b32 v13, v255
  s_nop 1
  v_permlane32_swap_b32 v12, v13
  s_nop 1
  v_add_f32 v255, v12, v13
  s_lshl_b32 s67, s48, 10
  s_add_u32 s67, s67, 153216
  v_lshlrev_b32 v12, 5, v3
  v_add_u32 v12, s67, v12
  s_mov_b64 exec, 0xffff
  ds_write_b128 v12, v[240:243] offset:0
  ds_write_b128 v12, v[244:247] offset:16
  ds_write_b128 v12, v[248:251] offset:512
  ds_write_b128 v12, v[252:255] offset:528
  s_mov_b64 exec, -1
  s_waitcnt lgkmcnt(0)
  s_barrier
  v_add_u32 v12, 153216, v20
  ds_read_b128 v[176:179], v12 offset:0
  ds_read_b128 v[180:183], v12 offset:1024
  ds_read_b128 v[184:187], v12 offset:2048
  ds_read_b128 v[188:191], v12 offset:3072
  ds_read_b128 v[192:195], v12 offset:4096
  ds_read_b128 v[196:199], v12 offset:5120
  ds_read_b128 v[200:203], v12 offset:6144
  ds_read_b128 v[204:207], v12 offset:7168
  s_waitcnt lgkmcnt(0)
  v_add_f32 v176, v176, v180
  v_add_f32 v177, v177, v181
  v_add_f32 v178, v178, v182
  v_add_f32 v179, v179, v183
  v_add_f32 v176, v176, v184
  v_add_f32 v177, v177, v185
  v_add_f32 v178, v178, v186
  v_add_f32 v179, v179, v187
  v_add_f32 v176, v176, v188
  v_add_f32 v177, v177, v189
  v_add_f32 v178, v178, v190
  v_add_f32 v179, v179, v191
  v_add_f32 v176, v176, v192
  v_add_f32 v177, v177, v193
  v_add_f32 v178, v178, v194
  v_add_f32 v179, v179, v195
  v_add_f32 v176, v176, v196
  v_add_f32 v177, v177, v197
  v_add_f32 v178, v178, v198
  v_add_f32 v179, v179, v199
  v_add_f32 v176, v176, v200
  v_add_f32 v177, v177, v201
  v_add_f32 v178, v178, v202
  v_add_f32 v179, v179, v203
  v_add_f32 v176, v176, v204
  v_add_f32 v177, v177, v205
  v_add_f32 v178, v178, v206
  v_add_f32 v179, v179, v207
  v_cvt_pk_bf16_f32 v180, v176, v177
  v_cvt_pk_bf16_f32 v181, v178, v179
  v_lshlrev_b32 v12, 3, v1
  v_add_u32 v12, 144512, v12
  ds_write_b64 v12, v[180:181]
  v_and_b32 v12, 1, v1
  v_lshlrev_b32 v12, 8, v12
  v_lshl_add_u32 v12, v2, 4, v12
  v_add_u32 v12, 144512, v12
  s_waitcnt lgkmcnt(0)
  ds_read_b128 v[176:179], v12 offset:0
  ds_read_b128 v[180:183], v12 offset:64
  ds_read_b128 v[184:187], v12 offset:128
  ds_read_b128 v[188:191], v12 offset:192
  s_waitcnt vmcnt(0) lgkmcnt(0)
  v_mfma_f32_16x16x32_bf16 v[192:195], v[144:147], v[176:179], 0
  v_mfma_f32_16x16x32_bf16 v[192:195], v[148:151], v[180:183], v[192:195]
  v_mfma_f32_16x16x32_bf16 v[192:195], v[152:155], v[184:187], v[192:195]
  v_mfma_f32_16x16x32_bf16 v[192:195], v[156:159], v[188:191], v[192:195]
  v_mfma_f32_16x16x32_bf16 v[196:199], v[160:163], v[176:179], 0
  v_mfma_f32_16x16x32_bf16 v[196:199], v[164:167], v[180:183], v[196:199]
  v_mfma_f32_16x16x32_bf16 v[196:199], v[168:171], v[184:187], v[196:199]
  v_mfma_f32_16x16x32_bf16 v[196:199], v[172:175], v[188:191], v[196:199]
  v_lshlrev_b32 v12, 15, v3
  v_lshrrev_b32 v13, 1, v2
  v_lshl_add_u32 v12, v13, 8, v12
  v_and_b32 v13, 1, v2
  v_lshl_add_u32 v12, v13, 3, v12
  s_lshr_b32 s66, s44, 4
  s_lshl_b32 s66, s66, 14
  s_lshl_b32 s67, s45, 13
  s_add_u32 s66, s66, s67
  s_lshl_b32 s67, s48, 10
  s_add_u32 s66, s66, s67
  s_and_b32 s67, s44, 15
  s_lshl_b32 s67, s67, 4
  s_add_u32 s66, s66, s67
  s_add_u32 s92, s42, s66
  s_addc_u32 s93, s43, 0
  s_add_u32 s92, s92, 65536
  s_addc_u32 s93, s93, 0
  s_nop 7
  v_cvt_pk_bf16_f32 v200, v192, v193
  v_cvt_pk_bf16_f32 v201, v194, v195
  v_cvt_pk_bf16_f32 v202, v196, v197
  v_cvt_pk_bf16_f32 v203, v198, v199
  s_mov_b32 s66, 0x00030003
  s_mov_b32 s67, 0x00030003
  s_mov_b64 exec, s[66:67]
  global_store_dwordx2 v12, v[200:201], s[92:93] offset:0 sc1
  global_store_dwordx2 v12, v[202:203], s[92:93] offset:512 sc1
  s_mov_b64 exec, -1
  s_cmp_eq_u32 s48, 0
  s_cbranch_scc1 L_sk_2
  s_lshl_b32 s67, s48, 13
  s_add_u32 s67, s67, 0
  s_mul_i32 s68, s48, 8448
  s_add_u32 s68, s68, 0
  s_mov_b32 m0, s68
  s_add_u32 s68, s68, 1056
  buffer_load_dwordx4 v20, s[60:63], s67 offen nt lds
  s_add_u32 s67, s67, 1024
  s_mov_b32 m0, s68
  s_add_u32 s68, s68, 1056
  buffer_load_dwordx4 v20, s[60:63], s67 offen nt lds
  s_add_u32 s67, s67, 1024
  s_mov_b32 m0, s68
  s_add_u32 s68, s68, 1056
  buffer_load_dwordx4 v20, s[60:63], s67 offen nt lds
  s_add_u32 s67, s67, 1024
  s_mov_b32 m0, s68
  s_add_u32 s68, s68, 1056
  buffer_load_dwordx4 v20, s[60:63], s67 offen nt lds
  s_add_u32 s67, s67, 1024
  s_mov_b32 m0, s68
  s_add_u32 s68, s68, 1056
  buffer_load_dwordx4 v20, s[60:63], s67 offen nt lds
  s_add_u32 s67, s67, 1024
  s_mov_b32 m0, s68
  s_add_u32 s68, s68, 1056
  buffer_load_dwordx4 v20, s[60:63], s67 offen nt lds
  s_add_u32 s67, s67, 1024
  s_mov_b32 m0, s68
  s_add_u32 s68, s68, 1056
  buffer_load_dwordx4 v20, s[60:63], s67 offen nt lds
  s_add_u32 s67, s67, 1024
  s_mov_b32 m0, s68
  s_add_u32 s68, s68, 1056
  buffer_load_dwordx4 v20, s[60:63], s67 offen nt lds
  s_add_u32 s67, s67, 1024
  s_lshl_b32 s67, s48, 13
  s_add_u32 s67, s67, 65536
  s_mul_i32 s68, s48, 8448
  s_add_u32 s68, s68, 67584
  s_mov_b32 m0, s68
  s_add_u32 s68, s68, 1056
  buffer_load_dwordx4 v20, s[60:63], s67 offen nt lds
  s_add_u32 s67, s67, 1024
  s_mov_b32 m0, s68
  s_add_u32 s68, s68, 1056
  buffer_load_dwordx4 v20, s[60:63], s67 offen nt lds
  s_add_u32 s67, s67, 1024
  s_mov_b32 m0, s68
  s_add_u32 s68, s68, 1056
  buffer_load_dwordx4 v20, s[60:63], s67 offen nt lds
  s_add_u32 s67, s67, 1024
  s_mov_b32 m0, s68
  s_add_u32 s68, s68, 1056
  buffer_load_dwordx4 v20, s[60:63], s67 offen nt lds
  s_add_u32 s67, s67, 1024
  s_mov_b32 m0, s68
  s_add_u32 s68, s68, 1056
  buffer_load_dwordx4 v20, s[60:63], s67 offen nt lds
  s_add_u32 s67, s67, 1024
  s_mov_b32 m0, s68
  s_add_u32 s68, s68, 1056
  buffer_load_dwordx4 v20, s[60:63], s67 offen nt lds
  s_add_u32 s67, s67, 1024
  s_mov_b32 m0, s68
  s_add_u32 s68, s68, 1056
  buffer_load_dwordx4 v20, s[60:63], s67 offen nt lds
  s_add_u32 s67, s67, 1024
  s_mov_b32 m0, s68
  s_add_u32 s68, s68, 1056
  buffer_load_dwordx4 v20, s[60:63], s67 offen nt lds
  s_add_u32 s67, s67, 1024
  s_lshl_b32 s67, s48, 13
  s_add_u32 s67, s67, 131072
  buffer_load_dwordx4 v[192:195], v20, s[60:63], s67 offen nt
  s_add_u32 s67, s67, 1024
  buffer_load_dwordx4 v[196:199], v20, s[60:63], s67 offen nt
  s_add_u32 s67, s67, 1024
  buffer_load_dwordx4 v[200:203], v20, s[60:63], s67 offen nt
  s_add_u32 s67, s67, 1024
  buffer_load_dwordx4 v[204:207], v20, s[60:63], s67 offen nt
  s_add_u32 s67, s67, 1024
  buffer_load_dwordx4 v[208:211], v20, s[60:63], s67 offen nt
  s_add_u32 s67, s67, 1024
  buffer_load_dwordx4 v[212:215], v20, s[60:63], s67 offen nt
  s_add_u32 s67, s67, 1024
  buffer_load_dwordx4 v[216:219], v20, s[60:63], s67 offen nt
  s_add_u32 s67, s67, 1024
  buffer_load_dwordx4 v[220:223], v20, s[60:63], s67 offen nt
  s_waitcnt vmcnt(24)
  s_barrier
  s_branch L_sk_3
L_sk_2:
  s_waitcnt vmcnt(0)
  s_barrier
  s_mov_b64 exec, 1
  v_mov_b32 v12, 1
  global_atomic_add v12, v4, v12, s[40:41] offset:0 sc0 sc1
  s_waitcnt vmcnt(0)
  v_readfirstlane_b32 s66, v12
  s_mov_b64 exec, -1
  s_and_b32 s66, s66, 63
  s_cmp_eq_u32 s66, 63
  s_cbranch_scc0 L_nl_4
  s_add_u32 s90, s42, 999424
  s_addc_u32 s91, s43, 0
  v_lshlrev_b32 v12, 7, v1
  v_mov_b32 v13, 1
  global_store_dword v12, v13, s[90:91] sc1
L_nl_4:
  s_lshl_b32 s67, s48, 13
  s_add_u32 s67, s67, 0
  s_mul_i32 s68, s48, 8448
  s_add_u32 s68, s68, 0
  s_mov_b32 m0, s68
  s_add_u32 s68, s68, 1056
  buffer_load_dwordx4 v20, s[60:63], s67 offen nt lds
  s_add_u32 s67, s67, 1024
  s_mov_b32 m0, s68
  s_add_u32 s68, s68, 1056
  buffer_load_dwordx4 v20, s[60:63], s67 offen nt lds
  s_add_u32 s67, s67, 1024
  s_mov_b32 m0, s68
  s_add_u32 s68, s68, 1056
  buffer_load_dwordx4 v20, s[60:63], s67 offen nt lds
  s_add_u32 s67, s67, 1024
  s_mov_b32 m0, s68
  s_add_u32 s68, s68, 1056
  buffer_load_dwordx4 v20, s[60:63], s67 offen nt lds
  s_add_u32 s67, s67, 1024
  s_mov_b32 m0, s68
  s_add_u32 s68, s68, 1056
  buffer_load_dwordx4 v20, s[60:63], s67 offen nt lds
  s_add_u32 s67, s67, 1024
  s_mov_b32 m0, s68
  s_add_u32 s68, s68, 1056
  buffer_load_dwordx4 v20, s[60:63], s67 offen nt lds
  s_add_u32 s67, s67, 1024
  s_mov_b32 m0, s68
  s_add_u32 s68, s68, 1056
  buffer_load_dwordx4 v20, s[60:63], s67 offen nt lds
  s_add_u32 s67, s67, 1024
  s_mov_b32 m0, s68
  s_add_u32 s68, s68, 1056
  buffer_load_dwordx4 v20, s[60:63], s67 offen nt lds
  s_add_u32 s67, s67, 1024
  s_lshl_b32 s67, s48, 13
  s_add_u32 s67, s67, 65536
  s_mul_i32 s68, s48, 8448
  s_add_u32 s68, s68, 67584
  s_mov_b32 m0, s68
  s_add_u32 s68, s68, 1056
  buffer_load_dwordx4 v20, s[60:63], s67 offen nt lds
  s_add_u32 s67, s67, 1024
  s_mov_b32 m0, s68
  s_add_u32 s68, s68, 1056
  buffer_load_dwordx4 v20, s[60:63], s67 offen nt lds
  s_add_u32 s67, s67, 1024
  s_mov_b32 m0, s68
  s_add_u32 s68, s68, 1056
  buffer_load_dwordx4 v20, s[60:63], s67 offen nt lds
  s_add_u32 s67, s67, 1024
  s_mov_b32 m0, s68
  s_add_u32 s68, s68, 1056
  buffer_load_dwordx4 v20, s[60:63], s67 offen nt lds
  s_add_u32 s67, s67, 1024
  s_mov_b32 m0, s68
  s_add_u32 s68, s68, 1056
  buffer_load_dwordx4 v20, s[60:63], s67 offen nt lds
  s_add_u32 s67, s67, 1024
  s_mov_b32 m0, s68
  s_add_u32 s68, s68, 1056
  buffer_load_dwordx4 v20, s[60:63], s67 offen nt lds
  s_add_u32 s67, s67, 1024
  s_mov_b32 m0, s68
  s_add_u32 s68, s68, 1056
  buffer_load_dwordx4 v20, s[60:63], s67 offen nt lds
  s_add_u32 s67, s67, 1024
  s_mov_b32 m0, s68
  s_add_u32 s68, s68, 1056
  buffer_load_dwordx4 v20, s[60:63], s67 offen nt lds
  s_add_u32 s67, s67, 1024
  s_lshl_b32 s67, s48, 13
  s_add_u32 s67, s67, 131072
  buffer_load_dwordx4 v[192:195], v20, s[60:63], s67 offen nt
  s_add_u32 s67, s67, 1024
  buffer_load_dwordx4 v[196:199], v20, s[60:63], s67 offen nt
  s_add_u32 s67, s67, 1024
  buffer_load_dwordx4 v[200:203], v20, s[60:63], s67 offen nt
  s_add_u32 s67, s67, 1024
  buffer_load_dwordx4 v[204:207], v20, s[60:63], s67 offen nt
  s_add_u32 s67, s67, 1024
  buffer_load_dwordx4 v[208:211], v20, s[60:63], s67 offen nt
  s_add_u32 s67, s67, 1024
  buffer_load_dwordx4 v[212:215], v20, s[60:63], s67 offen nt
  s_add_u32 s67, s67, 1024
  buffer_load_dwordx4 v[216:219], v20, s[60:63], s67 offen nt
  s_add_u32 s67, s67, 1024
  buffer_load_dwordx4 v[220:223], v20, s[60:63], s67 offen nt
  s_lshl_b32 s66, s2, 7
  s_add_u32 s90, s42, s66
  s_addc_u32 s91, s43, 0
  s_add_u32 s90, s90, 999424
  s_addc_u32 s91, s91, 0
  s_mov_b32 s79, 0
L_poll_5:
  global_load_dword v12, v4, s[90:91] offset:0 sc1
  s_waitcnt vmcnt(0)
  v_readfirstlane_b32 s66, v12
  s_cmp_ge_u32 s66, 1
  s_cbranch_scc1 L_polld_6
  s_sleep 1
  s_add_u32 s79, s79, 1
  s_cmp_lt_u32 s79, 0x20000
  s_cbranch_scc1 L_poll_5
L_polld_6:
L_sk_3:
  s_barrier
  s_and_b32 s68, s48, 3
  s_lshr_b32 s69, s48, 2
  s_lshl_b32 s66, s49, 15
  s_lshl_b32 s67, s69, 14
  s_add_u32 s66, s66, s67
  s_add_u32 s92, s42, s66
  s_addc_u32 s93, s43, 0
  s_add_u32 s92, s92, 69632
  s_addc_u32 s93, s93, 0
  global_load_dwordx4 v[64:67], v20, s[92:93] offset:-4096 sc1
  global_load_dwordx4 v[68:71], v20, s[92:93] offset:-3072 sc1
  global_load_dwordx4 v[72:75], v20, s[92:93] offset:-2048 sc1
  global_load_dwordx4 v[76:79], v20, s[92:93] offset:-1024 sc1
  global_load_dwordx4 v[80:83], v20, s[92:93] offset:0 sc1
  global_load_dwordx4 v[84:87], v20, s[92:93] offset:1024 sc1
  global_load_dwordx4 v[88:91], v20, s[92:93] offset:2048 sc1
  global_load_dwordx4 v[92:95], v20, s[92:93] offset:3072 sc1
  s_add_u32 s92, s92, 8192
  s_addc_u32 s93, s93, 0
  global_load_dwordx4 v[96:99], v20, s[92:93] offset:-4096 sc1
  global_load_dwordx4 v[100:103], v20, s[92:93] offset:-3072 sc1
  global_load_dwordx4 v[104:107], v20, s[92:93] offset:-2048 sc1
  global_load_dwordx4 v[108:111], v20, s[92:93] offset:-1024 sc1
  global_load_dwordx4 v[112:115], v20, s[92:93] offset:0 sc1
  global_load_dwordx4 v[116:119], v20, s[92:93] offset:1024 sc1
  global_load_dwordx4 v[120:123], v20, s[92:93] offset:2048 sc1
  global_load_dwordx4 v[124:127], v20, s[92:93] offset:3072 sc1
  s_lshl_b32 s66, s68, 4
  v_add_u32 v21, s66, v3
  v_mul_u32_u24 v21, 1056, v21
  v_lshl_add_u32 v21, v2, 4, v21
  v_add_u32 v22, 67584, v21
  v_lshrrev_b32 v23, 2, v3
  v_lshl_add_u32 v23, v2, 2, v23
  v_mul_u32_u24 v23, 1056, v23
  v_and_b32 v24, 3, v1
  v_lshl_add_u32 v23, v24, 3, v23
  s_lshl_b32 s66, s48, 7
  v_add_u32 v23, s66, v23
  v_add_u32 v24, 67584, v23
  s_lshl_b32 s66, s69, 4
  v_add_u32 v26, s66, v3
  v_lshlrev_b32 v27, 6, v26
  v_add_u32 v27, 140288, v27
  s_lshl_b32 s66, s68, 4
  v_lshl_add_u32 v25, v2, 2, v27
  v_add_u32 v25, s66, v25
  v_mul_u32_u24 v28, 160, v26
  v_lshl_add_u32 v28, v2, 4, v28
  s_lshr_b32 s66, s68, 1
  s_lshl_b32 s66, s66, 6
  s_and_b32 s67, s68, 1
  s_lshl_b32 s67, s67, 3
  s_add_u32 s66, s66, s67
  s_add_u32 s66, s66, 135168
  v_add_u32 v28, s66, v28
  v_mul_u32_u24 v29, 160, v3
  v_lshl_add_u32 v29, v2, 4, v29
  v_add_u32 v29, 135168, v29
  v_lshlrev_b32 v30, 2, v26
  v_add_u32 v30, 142336, v30
  v_lshlrev_b32 v31, 2, v3
  v_add_u32 v31, 142336, v31
  v_mov_b32 v32, 0xf149f2ca
  v_mov_b32 v33, 0
  v_mov_b32 v128, 0
  v_mov_b32 v129, 0
  v_mov_b32 v130, 0
  v_mov_b32 v131, 0
  v_mov_b32 v132, 0
  v_mov_b32 v133, 0
  v_mov_b32 v134, 0
  v_mov_b32 v135, 0
  v_mov_b32 v136, 0
  v_mov_b32 v137, 0
  v_mov_b32 v138, 0
  v_mov_b32 v139, 0
  v_mov_b32 v140, 0
  v_mov_b32 v141, 0
  v_mov_b32 v142, 0
  v_mov_b32 v143, 0
  v_mov_b32 v144, 0
  v_mov_b32 v145, 0
  v_mov_b32 v146, 0
  v_mov_b32 v147, 0
  v_mov_b32 v148, 0
  v_mov_b32 v149, 0
  v_mov_b32 v150, 0
  v_mov_b32 v151, 0
  v_mov_b32 v152, 0
  v_mov_b32 v153, 0
  v_mov_b32 v154, 0
  v_mov_b32 v155, 0
  v_mov_b32 v156, 0
  v_mov_b32 v157, 0
  v_mov_b32 v158, 0
  v_mov_b32 v159, 0
  s_mov_b32 s75, s68
  s_waitcnt vmcnt(0)
  s_barrier
  ds_read_b128 v[160:163], v21 offset:0
  ds_read_b128 v[164:167], v21 offset:64
  ds_read_b128 v[168:171], v21 offset:128
  ds_read_b128 v[172:175], v21 offset:192
  ds_read_b128 v[176:179], v21 offset:256
  ds_read_b128 v[180:183], v21 offset:320
  ds_read_b128 v[184:187], v21 offset:384
  ds_read_b128 v[188:191], v21 offset:448
  s_waitcnt lgkmcnt(7)
  v_mfma_f32_16x16x32_bf16 v[36:39], v[160:163], v[64:67], 0
  s_waitcnt lgkmcnt(6)
  v_mfma_f32_16x16x32_bf16 v[36:39], v[164:167], v[68:71], v[36:39]
  s_waitcnt lgkmcnt(5)
  v_mfma_f32_16x16x32_bf16 v[36:39], v[168:171], v[72:75], v[36:39]
  s_waitcnt lgkmcnt(4)
  v_mfma_f32_16x16x32_bf16 v[36:39], v[172:175], v[76:79], v[36:39]
  s_waitcnt lgkmcnt(3)
  v_mfma_f32_16x16x32_bf16 v[36:39], v[176:179], v[80:83], v[36:39]
  s_waitcnt lgkmcnt(2)
  v_mfma_f32_16x16x32_bf16 v[36:39], v[180:183], v[84:87], v[36:39]
  s_waitcnt lgkmcnt(1)
  v_mfma_f32_16x16x32_bf16 v[36:39], v[184:187], v[88:91], v[36:39]
  s_waitcnt lgkmcnt(0)
  v_mfma_f32_16x16x32_bf16 v[36:39], v[188:191], v[92:95], v[36:39]
  ds_read_b128 v[160:163], v21 offset:512
  ds_read_b128 v[164:167], v21 offset:576
  ds_read_b128 v[168:171], v21 offset:640
  ds_read_b128 v[172:175], v21 offset:704
  ds_read_b128 v[176:179], v21 offset:768
  ds_read_b128 v[180:183], v21 offset:832
  ds_read_b128 v[184:187], v21 offset:896
  ds_read_b128 v[188:191], v21 offset:960
  s_waitcnt lgkmcnt(7)
  v_mfma_f32_16x16x32_bf16 v[36:39], v[160:163], v[96:99], v[36:39]
  s_waitcnt lgkmcnt(6)
  v_mfma_f32_16x16x32_bf16 v[36:39], v[164:167], v[100:103], v[36:39]
  s_waitcnt lgkmcnt(5)
  v_mfma_f32_16x16x32_bf16 v[36:39], v[168:171], v[104:107], v[36:39]
  s_waitcnt lgkmcnt(4)
  v_mfma_f32_16x16x32_bf16 v[36:39], v[172:175], v[108:111], v[36:39]
  s_waitcnt lgkmcnt(3)
  v_mfma_f32_16x16x32_bf16 v[36:39], v[176:179], v[112:115], v[36:39]
  s_waitcnt lgkmcnt(2)
  v_mfma_f32_16x16x32_bf16 v[36:39], v[180:183], v[116:119], v[36:39]
  s_waitcnt lgkmcnt(1)
  v_mfma_f32_16x16x32_bf16 v[36:39], v[184:187], v[120:123], v[36:39]
  s_waitcnt lgkmcnt(0)
  v_mfma_f32_16x16x32_bf16 v[36:39], v[188:191], v[124:127], v[36:39]
  s_nop 7
  s_nop 0
  v_max3_f32 v40, v36, v37, v38
  v_max_f32 v40, v40, v39
  ds_write_b32 v25, v40
  s_waitcnt lgkmcnt(0)
  s_barrier
  ds_read_b128 v[40:43], v27 offset:0
  ds_read_b128 v[44:47], v27 offset:16
  ds_read_b128 v[48:51], v27 offset:32
  ds_read_b128 v[52:55], v27 offset:48
  s_waitcnt lgkmcnt(0)
  v_max3_f32 v40, v40, v41, v42
  v_max_f32 v40, v40, v43
  v_max3_f32 v44, v44, v45, v46
  v_max_f32 v44, v44, v47
  v_max3_f32 v48, v48, v49, v50
  v_max_f32 v48, v48, v51
  v_max3_f32 v52, v52, v53, v54
  v_max_f32 v52, v52, v55
  v_max3_f32 v40, v40, v44, v48
  v_max_f32 v40, v40, v52
  v_mul_f32 v40, s82, v40
  v_max_f32 v40, v40, v32
  v_sub_f32 v41, v32, v40
  v_exp_f32 v41, v41
  v_mov_b32 v32, v40
  v_fma_f32 v44, v36, s82, -v40
  v_fma_f32 v45, v37, s82, -v40
  v_fma_f32 v46, v38, s82, -v40
  v_fma_f32 v47, v39, s82, -v40
  v_exp_f32 v44, v44
  v_exp_f32 v45, v45
  v_exp_f32 v46, v46
  v_exp_f32 v47, v47
  v_mul_f32 v33, v33, v41
  v_cvt_pk_bf16_f32 v48, v44, v45
  v_cvt_pk_bf16_f32 v49, v46, v47
  v_add_f32 v44, v44, v45
  v_add_f32 v46, v46, v47
  ds_write_b64 v28, v[48:49]
  ds_write_b32 v30, v41
  v_add_f32 v33, v33, v44
  v_add_f32 v33, v33, v46
  s_waitcnt lgkmcnt(0)
  s_barrier
  ds_read_b32 v240, v31 offset:0
  ds_read_b32 v241, v31 offset:64
  ds_read_b128 v[224:227], v29 offset:0
  ds_read_b128 v[228:231], v29 offset:64
  ds_read_b128 v[232:235], v29 offset:2560
  ds_read_b128 v[236:239], v29 offset:2624
  ds_read_b64_tr_b16 v[160:161], v23 offset:0
  ds_read_b64_tr_b16 v[162:163], v23 offset:16896
  ds_read_b64_tr_b16 v[164:165], v23 offset:32
  ds_read_b64_tr_b16 v[166:167], v23 offset:16928
  ds_read_b64_tr_b16 v[168:169], v23 offset:64
  ds_read_b64_tr_b16 v[170:171], v23 offset:16960
  ds_read_b64_tr_b16 v[172:173], v23 offset:96
  ds_read_b64_tr_b16 v[174:175], v23 offset:16992
  ds_read_b64_tr_b16 v[176:177], v23 offset:33792
  ds_read_b64_tr_b16 v[178:179], v23 offset:50688
  ds_read_b64_tr_b16 v[180:181], v23 offset:33824
  ds_read_b64_tr_b16 v[182:183], v23 offset:50720
  ds_read_b64_tr_b16 v[184:185], v23 offset:33856
  ds_read_b64_tr_b16 v[186:187], v23 offset:50752
  ds_read_b64_tr_b16 v[188:189], v23 offset:33888
  ds_read_b64_tr_b16 v[190:191], v23 offset:50784
  s_waitcnt lgkmcnt(15)
  v_mul_f32 v128, v128, v240
  v_mul_f32 v129, v129, v240
  v_mul_f32 v130, v130, v240
  v_mul_f32 v131, v131, v240
  v_mul_f32 v132, v132, v240
  v_mul_f32 v133, v133, v240
  v_mul_f32 v134, v134, v240
  v_mul_f32 v135, v135, v240
  v_mul_f32 v136, v136, v240
  v_mul_f32 v137, v137, v240
  v_mul_f32 v138, v138, v240
  v_mul_f32 v139, v139, v240
  v_mul_f32 v140, v140, v240
  v_mul_f32 v141, v141, v240
  v_mul_f32 v142, v142, v240
  v_mul_f32 v143, v143, v240
  v_mul_f32 v144, v144, v241
  v_mul_f32 v145, v145, v241
  v_mul_f32 v146, v146, v241
  v_mul_f32 v147, v147, v241
  v_mul_f32 v148, v148, v241
  v_mul_f32 v149, v149, v241
  v_mul_f32 v150, v150, v241
  v_mul_f32 v151, v151, v241
  v_mul_f32 v152, v152, v241
  v_mul_f32 v153, v153, v241
  v_mul_f32 v154, v154, v241
  v_mul_f32 v155, v155, v241
  v_mul_f32 v156, v156, v241
  v_mul_f32 v157, v157, v241
  v_mul_f32 v158, v158, v241
  v_mul_f32 v159, v159, v241
  s_waitcnt lgkmcnt(0)
  v_mfma_f32_16x16x32_bf16 v[128:131], v[160:163], v[224:227], v[128:131]
  v_mfma_f32_16x16x32_bf16 v[144:147], v[160:163], v[232:235], v[144:147]
  v_mfma_f32_16x16x32_bf16 v[132:135], v[164:167], v[224:227], v[132:135]
  v_mfma_f32_16x16x32_bf16 v[148:151], v[164:167], v[232:235], v[148:151]
  v_mfma_f32_16x16x32_bf16 v[136:139], v[168:171], v[224:227], v[136:139]
  v_mfma_f32_16x16x32_bf16 v[152:155], v[168:171], v[232:235], v[152:155]
  v_mfma_f32_16x16x32_bf16 v[140:143], v[172:175], v[224:227], v[140:143]
  v_mfma_f32_16x16x32_bf16 v[156:159], v[172:175], v[232:235], v[156:159]
  v_mfma_f32_16x16x32_bf16 v[128:131], v[176:179], v[228:231], v[128:131]
  v_mfma_f32_16x16x32_bf16 v[144:147], v[176:179], v[236:239], v[144:147]
  v_mfma_f32_16x16x32_bf16 v[132:135], v[180:183], v[228:231], v[132:135]
  v_mfma_f32_16x16x32_bf16 v[148:151], v[180:183], v[236:239], v[148:151]
  v_mfma_f32_16x16x32_bf16 v[136:139], v[184:187], v[228:231], v[136:139]
  v_mfma_f32_16x16x32_bf16 v[152:155], v[184:187], v[236:239], v[152:155]
  v_mfma_f32_16x16x32_bf16 v[140:143], v[188:191], v[228:231], v[140:143]
  v_mfma_f32_16x16x32_bf16 v[156:159], v[188:191], v[236:239], v[156:159]
  s_barrier
  s_mul_i32 s68, s48, 8448
  s_add_u32 s68, s68, 0
  v_add_u32 v40, s68, v20
  ds_write_b128 v40, v[192:195] offset:0
  ds_write_b128 v40, v[196:199] offset:1056
  ds_write_b128 v40, v[200:203] offset:2112
  ds_write_b128 v40, v[204:207] offset:3168
  ds_write_b128 v40, v[208:211] offset:4224
  ds_write_b128 v40, v[212:215] offset:5280
  ds_write_b128 v40, v[216:219] offset:6336
  ds_write_b128 v40, v[220:223] offset:7392
  s_waitcnt lgkmcnt(0)
  s_lshl_b32 s67, s48, 13
  s_add_u32 s67, s67, 196608
  buffer_load_dwordx4 v[192:195], v20, s[60:63], s67 offen nt
  s_add_u32 s67, s67, 1024
  buffer_load_dwordx4 v[196:199], v20, s[60:63], s67 offen nt
  s_add_u32 s67, s67, 1024
  buffer_load_dwordx4 v[200:203], v20, s[60:63], s67 offen nt
  s_add_u32 s67, s67, 1024
  buffer_load_dwordx4 v[204:207], v20, s[60:63], s67 offen nt
  s_add_u32 s67, s67, 1024
  buffer_load_dwordx4 v[208:211], v20, s[60:63], s67 offen nt
  s_add_u32 s67, s67, 1024
  buffer_load_dwordx4 v[212:215], v20, s[60:63], s67 offen nt
  s_add_u32 s67, s67, 1024
  buffer_load_dwordx4 v[216:219], v20, s[60:63], s67 offen nt
  s_add_u32 s67, s67, 1024
  buffer_load_dwordx4 v[220:223], v20, s[60:63], s67 offen nt
  ds_read_b128 v[160:163], v22 offset:0
  ds_read_b128 v[164:167], v22 offset:64
  ds_read_b128 v[168:171], v22 offset:128
  ds_read_b128 v[172:175], v22 offset:192
  ds_read_b128 v[176:179], v22 offset:256
  ds_read_b128 v[180:183], v22 offset:320
  ds_read_b128 v[184:187], v22 offset:384
  ds_read_b128 v[188:191], v22 offset:448
  s_waitcnt lgkmcnt(7)
  v_mfma_f32_16x16x32_bf16 v[36:39], v[160:163], v[64:67], 0
  s_waitcnt lgkmcnt(6)
  v_mfma_f32_16x16x32_bf16 v[36:39], v[164:167], v[68:71], v[36:39]
  s_waitcnt lgkmcnt(5)
  v_mfma_f32_16x16x32_bf16 v[36:39], v[168:171], v[72:75], v[36:39]
  s_waitcnt lgkmcnt(4)
  v_mfma_f32_16x16x32_bf16 v[36:39], v[172:175], v[76:79], v[36:39]
  s_waitcnt lgkmcnt(3)
  v_mfma_f32_16x16x32_bf16 v[36:39], v[176:179], v[80:83], v[36:39]
  s_waitcnt lgkmcnt(2)
  v_mfma_f32_16x16x32_bf16 v[36:39], v[180:183], v[84:87], v[36:39]
  s_waitcnt lgkmcnt(1)
  v_mfma_f32_16x16x32_bf16 v[36:39], v[184:187], v[88:91], v[36:39]
  s_waitcnt lgkmcnt(0)
  v_mfma_f32_16x16x32_bf16 v[36:39], v[188:191], v[92:95], v[36:39]
  ds_read_b128 v[160:163], v22 offset:512
  ds_read_b128 v[164:167], v22 offset:576
  ds_read_b128 v[168:171], v22 offset:640
  ds_read_b128 v[172:175], v22 offset:704
  ds_read_b128 v[176:179], v22 offset:768
  ds_read_b128 v[180:183], v22 offset:832
  ds_read_b128 v[184:187], v22 offset:896
  ds_read_b128 v[188:191], v22 offset:960
  s_waitcnt lgkmcnt(7)
  v_mfma_f32_16x16x32_bf16 v[36:39], v[160:163], v[96:99], v[36:39]
  s_waitcnt lgkmcnt(6)
  v_mfma_f32_16x16x32_bf16 v[36:39], v[164:167], v[100:103], v[36:39]
  s_waitcnt lgkmcnt(5)
  v_mfma_f32_16x16x32_bf16 v[36:39], v[168:171], v[104:107], v[36:39]
  s_waitcnt lgkmcnt(4)
  v_mfma_f32_16x16x32_bf16 v[36:39], v[172:175], v[108:111], v[36:39]
  s_waitcnt lgkmcnt(3)
  v_mfma_f32_16x16x32_bf16 v[36:39], v[176:179], v[112:115], v[36:39]
  s_waitcnt lgkmcnt(2)
  v_mfma_f32_16x16x32_bf16 v[36:39], v[180:183], v[116:119], v[36:39]
  s_waitcnt lgkmcnt(1)
  v_mfma_f32_16x16x32_bf16 v[36:39], v[184:187], v[120:123], v[36:39]
  s_waitcnt lgkmcnt(0)
  v_mfma_f32_16x16x32_bf16 v[36:39], v[188:191], v[124:127], v[36:39]
  s_nop 7
  s_nop 0
  v_max3_f32 v40, v36, v37, v38
  v_max_f32 v40, v40, v39
  ds_write_b32 v25, v40
  s_waitcnt lgkmcnt(0)
  s_barrier
  ds_read_b128 v[40:43], v27 offset:0
  ds_read_b128 v[44:47], v27 offset:16
  ds_read_b128 v[48:51], v27 offset:32
  ds_read_b128 v[52:55], v27 offset:48
  s_waitcnt lgkmcnt(0)
  v_max3_f32 v40, v40, v41, v42
  v_max_f32 v40, v40, v43
  v_max3_f32 v44, v44, v45, v46
  v_max_f32 v44, v44, v47
  v_max3_f32 v48, v48, v49, v50
  v_max_f32 v48, v48, v51
  v_max3_f32 v52, v52, v53, v54
  v_max_f32 v52, v52, v55
  v_max3_f32 v40, v40, v44, v48
  v_max_f32 v40, v40, v52
  v_mul_f32 v40, s82, v40
  v_max_f32 v40, v40, v32
  v_sub_f32 v41, v32, v40
  v_exp_f32 v41, v41
  v_mov_b32 v32, v40
  v_fma_f32 v44, v36, s82, -v40
  v_fma_f32 v45, v37, s82, -v40
  v_fma_f32 v46, v38, s82, -v40
  v_fma_f32 v47, v39, s82, -v40
  v_exp_f32 v44, v44
  v_exp_f32 v45, v45
  v_exp_f32 v46, v46
  v_exp_f32 v47, v47
  v_mul_f32 v33, v33, v41
  v_cvt_pk_bf16_f32 v48, v44, v45
  v_cvt_pk_bf16_f32 v49, v46, v47
  v_add_f32 v44, v44, v45
  v_add_f32 v46, v46, v47
  ds_write_b64 v28, v[48:49]
  ds_write_b32 v30, v41
  v_add_f32 v33, v33, v44
  v_add_f32 v33, v33, v46
  s_waitcnt lgkmcnt(0)
  s_barrier
  ds_read_b32 v240, v31 offset:0
  ds_read_b32 v241, v31 offset:64
  ds_read_b128 v[224:227], v29 offset:0
  ds_read_b128 v[228:231], v29 offset:64
  ds_read_b128 v[232:235], v29 offset:2560
  ds_read_b128 v[236:239], v29 offset:2624
  ds_read_b64_tr_b16 v[160:161], v24 offset:0
  ds_read_b64_tr_b16 v[162:163], v24 offset:16896
  ds_read_b64_tr_b16 v[164:165], v24 offset:32
  ds_read_b64_tr_b16 v[166:167], v24 offset:16928
  ds_read_b64_tr_b16 v[168:169], v24 offset:64
  ds_read_b64_tr_b16 v[170:171], v24 offset:16960
  ds_read_b64_tr_b16 v[172:173], v24 offset:96
  ds_read_b64_tr_b16 v[174:175], v24 offset:16992
  ds_read_b64_tr_b16 v[176:177], v24 offset:33792
  ds_read_b64_tr_b16 v[178:179], v24 offset:50688
  ds_read_b64_tr_b16 v[180:181], v24 offset:33824
  ds_read_b64_tr_b16 v[182:183], v24 offset:50720
  ds_read_b64_tr_b16 v[184:185], v24 offset:33856
  ds_read_b64_tr_b16 v[186:187], v24 offset:50752
  ds_read_b64_tr_b16 v[188:189], v24 offset:33888
  ds_read_b64_tr_b16 v[190:191], v24 offset:50784
  s_waitcnt lgkmcnt(15)
  v_mul_f32 v128, v128, v240
  v_mul_f32 v129, v129, v240
  v_mul_f32 v130, v130, v240
  v_mul_f32 v131, v131, v240
  v_mul_f32 v132, v132, v240
  v_mul_f32 v133, v133, v240
  v_mul_f32 v134, v134, v240
  v_mul_f32 v135, v135, v240
  v_mul_f32 v136, v136, v240
  v_mul_f32 v137, v137, v240
  v_mul_f32 v138, v138, v240
  v_mul_f32 v139, v139, v240
  v_mul_f32 v140, v140, v240
  v_mul_f32 v141, v141, v240
  v_mul_f32 v142, v142, v240
  v_mul_f32 v143, v143, v240
  v_mul_f32 v144, v144, v241
  v_mul_f32 v145, v145, v241
  v_mul_f32 v146, v146, v241
  v_mul_f32 v147, v147, v241
  v_mul_f32 v148, v148, v241
  v_mul_f32 v149, v149, v241
  v_mul_f32 v150, v150, v241
  v_mul_f32 v151, v151, v241
  v_mul_f32 v152, v152, v241
  v_mul_f32 v153, v153, v241
  v_mul_f32 v154, v154, v241
  v_mul_f32 v155, v155, v241
  v_mul_f32 v156, v156, v241
  v_mul_f32 v157, v157, v241
  v_mul_f32 v158, v158, v241
  v_mul_f32 v159, v159, v241
  s_waitcnt lgkmcnt(0)
  v_mfma_f32_16x16x32_bf16 v[128:131], v[160:163], v[224:227], v[128:131]
  v_mfma_f32_16x16x32_bf16 v[144:147], v[160:163], v[232:235], v[144:147]
  v_mfma_f32_16x16x32_bf16 v[132:135], v[164:167], v[224:227], v[132:135]
  v_mfma_f32_16x16x32_bf16 v[148:151], v[164:167], v[232:235], v[148:151]
  v_mfma_f32_16x16x32_bf16 v[136:139], v[168:171], v[224:227], v[136:139]
  v_mfma_f32_16x16x32_bf16 v[152:155], v[168:171], v[232:235], v[152:155]
  v_mfma_f32_16x16x32_bf16 v[140:143], v[172:175], v[224:227], v[140:143]
  v_mfma_f32_16x16x32_bf16 v[156:159], v[172:175], v[232:235], v[156:159]
  v_mfma_f32_16x16x32_bf16 v[128:131], v[176:179], v[228:231], v[128:131]
  v_mfma_f32_16x16x32_bf16 v[144:147], v[176:179], v[236:239], v[144:147]
  v_mfma_f32_16x16x32_bf16 v[132:135], v[180:183], v[228:231], v[132:135]
  v_mfma_f32_16x16x32_bf16 v[148:151], v[180:183], v[236:239], v[148:151]
  v_mfma_f32_16x16x32_bf16 v[136:139], v[184:187], v[228:231], v[136:139]
  v_mfma_f32_16x16x32_bf16 v[152:155], v[184:187], v[236:239], v[152:155]
  v_mfma_f32_16x16x32_bf16 v[140:143], v[188:191], v[228:231], v[140:143]
  v_mfma_f32_16x16x32_bf16 v[156:159], v[188:191], v[236:239], v[156:159]
  s_waitcnt vmcnt(0)
  s_barrier
  s_mul_i32 s68, s48, 8448
  s_add_u32 s68, s68, 67584
  v_add_u32 v40, s68, v20
  ds_write_b128 v40, v[192:195] offset:0
  ds_write_b128 v40, v[196:199] offset:1056
  ds_write_b128 v40, v[200:203] offset:2112
  ds_write_b128 v40, v[204:207] offset:3168
  ds_write_b128 v40, v[208:211] offset:4224
  ds_write_b128 v40, v[212:215] offset:5280
  ds_write_b128 v40, v[216:219] offset:6336
  ds_write_b128 v40, v[220:223] offset:7392
  s_waitcnt lgkmcnt(0)
  ds_read_b128 v[160:163], v21 offset:0
  ds_read_b128 v[164:167], v21 offset:64
  ds_read_b128 v[168:171], v21 offset:128
  ds_read_b128 v[172:175], v21 offset:192
  ds_read_b128 v[176:179], v21 offset:256
  ds_read_b128 v[180:183], v21 offset:320
  ds_read_b128 v[184:187], v21 offset:384
  ds_read_b128 v[188:191], v21 offset:448
  s_waitcnt lgkmcnt(7)
  v_mfma_f32_16x16x32_bf16 v[36:39], v[160:163], v[64:67], 0
  s_waitcnt lgkmcnt(6)
  v_mfma_f32_16x16x32_bf16 v[36:39], v[164:167], v[68:71], v[36:39]
  s_waitcnt lgkmcnt(5)
  v_mfma_f32_16x16x32_bf16 v[36:39], v[168:171], v[72:75], v[36:39]
  s_waitcnt lgkmcnt(4)
  v_mfma_f32_16x16x32_bf16 v[36:39], v[172:175], v[76:79], v[36:39]
  s_waitcnt lgkmcnt(3)
  v_mfma_f32_16x16x32_bf16 v[36:39], v[176:179], v[80:83], v[36:39]
  s_waitcnt lgkmcnt(2)
  v_mfma_f32_16x16x32_bf16 v[36:39], v[180:183], v[84:87], v[36:39]
  s_waitcnt lgkmcnt(1)
  v_mfma_f32_16x16x32_bf16 v[36:39], v[184:187], v[88:91], v[36:39]
  s_waitcnt lgkmcnt(0)
  v_mfma_f32_16x16x32_bf16 v[36:39], v[188:191], v[92:95], v[36:39]
  ds_read_b128 v[160:163], v21 offset:512
  ds_read_b128 v[164:167], v21 offset:576
  ds_read_b128 v[168:171], v21 offset:640
  ds_read_b128 v[172:175], v21 offset:704
  ds_read_b128 v[176:179], v21 offset:768
  ds_read_b128 v[180:183], v21 offset:832
  ds_read_b128 v[184:187], v21 offset:896
  ds_read_b128 v[188:191], v21 offset:960
  s_waitcnt lgkmcnt(7)
  v_mfma_f32_16x16x32_bf16 v[36:39], v[160:163], v[96:99], v[36:39]
  s_waitcnt lgkmcnt(6)
  v_mfma_f32_16x16x32_bf16 v[36:39], v[164:167], v[100:103], v[36:39]
  s_waitcnt lgkmcnt(5)
  v_mfma_f32_16x16x32_bf16 v[36:39], v[168:171], v[104:107], v[36:39]
  s_waitcnt lgkmcnt(4)
  v_mfma_f32_16x16x32_bf16 v[36:39], v[172:175], v[108:111], v[36:39]
  s_waitcnt lgkmcnt(3)
  v_mfma_f32_16x16x32_bf16 v[36:39], v[176:179], v[112:115], v[36:39]
  s_waitcnt lgkmcnt(2)
  v_mfma_f32_16x16x32_bf16 v[36:39], v[180:183], v[116:119], v[36:39]
  s_waitcnt lgkmcnt(1)
  v_mfma_f32_16x16x32_bf16 v[36:39], v[184:187], v[120:123], v[36:39]
  s_waitcnt lgkmcnt(0)
  v_mfma_f32_16x16x32_bf16 v[36:39], v[188:191], v[124:127], v[36:39]
  s_nop 7
  s_nop 0
  v_max3_f32 v40, v36, v37, v38
  v_max_f32 v40, v40, v39
  ds_write_b32 v25, v40
  s_waitcnt lgkmcnt(0)
  s_barrier
  ds_read_b128 v[40:43], v27 offset:0
  ds_read_b128 v[44:47], v27 offset:16
  ds_read_b128 v[48:51], v27 offset:32
  ds_read_b128 v[52:55], v27 offset:48
  s_waitcnt lgkmcnt(0)
  v_max3_f32 v40, v40, v41, v42
  v_max_f32 v40, v40, v43
  v_max3_f32 v44, v44, v45, v46
  v_max_f32 v44, v44, v47
  v_max3_f32 v48, v48, v49, v50
  v_max_f32 v48, v48, v51
  v_max3_f32 v52, v52, v53, v54
  v_max_f32 v52, v52, v55
  v_max3_f32 v40, v40, v44, v48
  v_max_f32 v40, v40, v52
  v_mul_f32 v40, s82, v40
  v_max_f32 v40, v40, v32
  v_sub_f32 v41, v32, v40
  v_exp_f32 v41, v41
  v_mov_b32 v32, v40
  v_fma_f32 v44, v36, s82, -v40
  v_fma_f32 v45, v37, s82, -v40
  v_fma_f32 v46, v38, s82, -v40
  v_fma_f32 v47, v39, s82, -v40
  v_exp_f32 v44, v44
  v_exp_f32 v45, v45
  v_exp_f32 v46, v46
  v_exp_f32 v47, v47
  v_mul_f32 v33, v33, v41
  v_cvt_pk_bf16_f32 v48, v44, v45
  v_cvt_pk_bf16_f32 v49, v46, v47
  v_add_f32 v44, v44, v45
  v_add_f32 v46, v46, v47
  ds_write_b64 v28, v[48:49]
  ds_write_b32 v30, v41
  v_add_f32 v33, v33, v44
  v_add_f32 v33, v33, v46
  s_waitcnt lgkmcnt(0)
  s_barrier
  ds_read_b32 v240, v31 offset:0
  ds_read_b32 v241, v31 offset:64
  ds_read_b128 v[224:227], v29 offset:0
  ds_read_b128 v[228:231], v29 offset:64
  ds_read_b128 v[232:235], v29 offset:2560
  ds_read_b128 v[236:239], v29 offset:2624
  ds_read_b64_tr_b16 v[160:161], v23 offset:0
  ds_read_b64_tr_b16 v[162:163], v23 offset:16896
  ds_read_b64_tr_b16 v[164:165], v23 offset:32
  ds_read_b64_tr_b16 v[166:167], v23 offset:16928
  ds_read_b64_tr_b16 v[168:169], v23 offset:64
  ds_read_b64_tr_b16 v[170:171], v23 offset:16960
  ds_read_b64_tr_b16 v[172:173], v23 offset:96
  ds_read_b64_tr_b16 v[174:175], v23 offset:16992
  ds_read_b64_tr_b16 v[176:177], v23 offset:33792
  ds_read_b64_tr_b16 v[178:179], v23 offset:50688
  ds_read_b64_tr_b16 v[180:181], v23 offset:33824
  ds_read_b64_tr_b16 v[182:183], v23 offset:50720
  ds_read_b64_tr_b16 v[184:185], v23 offset:33856
  ds_read_b64_tr_b16 v[186:187], v23 offset:50752
  ds_read_b64_tr_b16 v[188:189], v23 offset:33888
  ds_read_b64_tr_b16 v[190:191], v23 offset:50784
  s_waitcnt lgkmcnt(15)
  v_mul_f32 v128, v128, v240
  v_mul_f32 v129, v129, v240
  v_mul_f32 v130, v130, v240
  v_mul_f32 v131, v131, v240
  v_mul_f32 v132, v132, v240
  v_mul_f32 v133, v133, v240
  v_mul_f32 v134, v134, v240
  v_mul_f32 v135, v135, v240
  v_mul_f32 v136, v136, v240
  v_mul_f32 v137, v137, v240
  v_mul_f32 v138, v138, v240
  v_mul_f32 v139, v139, v240
  v_mul_f32 v140, v140, v240
  v_mul_f32 v141, v141, v240
  v_mul_f32 v142, v142, v240
  v_mul_f32 v143, v143, v240
  v_mul_f32 v144, v144, v241
  v_mul_f32 v145, v145, v241
  v_mul_f32 v146, v146, v241
  v_mul_f32 v147, v147, v241
  v_mul_f32 v148, v148, v241
  v_mul_f32 v149, v149, v241
  v_mul_f32 v150, v150, v241
  v_mul_f32 v151, v151, v241
  v_mul_f32 v152, v152, v241
  v_mul_f32 v153, v153, v241
  v_mul_f32 v154, v154, v241
  v_mul_f32 v155, v155, v241
  v_mul_f32 v156, v156, v241
  v_mul_f32 v157, v157, v241
  v_mul_f32 v158, v158, v241
  v_mul_f32 v159, v159, v241
  s_waitcnt lgkmcnt(0)
  v_mfma_f32_16x16x32_bf16 v[128:131], v[160:163], v[224:227], v[128:131]
  v_mfma_f32_16x16x32_bf16 v[144:147], v[160:163], v[232:235], v[144:147]
  v_mfma_f32_16x16x32_bf16 v[132:135], v[164:167], v[224:227], v[132:135]
  v_mfma_f32_16x16x32_bf16 v[148:151], v[164:167], v[232:235], v[148:151]
  v_mfma_f32_16x16x32_bf16 v[136:139], v[168:171], v[224:227], v[136:139]
  v_mfma_f32_16x16x32_bf16 v[152:155], v[168:171], v[232:235], v[152:155]
  v_mfma_f32_16x16x32_bf16 v[140:143], v[172:175], v[224:227], v[140:143]
  v_mfma_f32_16x16x32_bf16 v[156:159], v[172:175], v[232:235], v[156:159]
  v_mfma_f32_16x16x32_bf16 v[128:131], v[176:179], v[228:231], v[128:131]
  v_mfma_f32_16x16x32_bf16 v[144:147], v[176:179], v[236:239], v[144:147]
  v_mfma_f32_16x16x32_bf16 v[132:135], v[180:183], v[228:231], v[132:135]
  v_mfma_f32_16x16x32_bf16 v[148:151], v[180:183], v[236:239], v[148:151]
  v_mfma_f32_16x16x32_bf16 v[136:139], v[184:187], v[228:231], v[136:139]
  v_mfma_f32_16x16x32_bf16 v[152:155], v[184:187], v[236:239], v[152:155]
  v_mfma_f32_16x16x32_bf16 v[140:143], v[188:191], v[228:231], v[140:143]
  v_mfma_f32_16x16x32_bf16 v[156:159], v[188:191], v[236:239], v[156:159]
  s_barrier
  ds_read_b128 v[160:163], v22 offset:0
  ds_read_b128 v[164:167], v22 offset:64
  ds_read_b128 v[168:171], v22 offset:128
  ds_read_b128 v[172:175], v22 offset:192
  ds_read_b128 v[176:179], v22 offset:256
  ds_read_b128 v[180:183], v22 offset:320
  ds_read_b128 v[184:187], v22 offset:384
  ds_read_b128 v[188:191], v22 offset:448
  s_waitcnt lgkmcnt(7)
  v_mfma_f32_16x16x32_bf16 v[36:39], v[160:163], v[64:67], 0
  s_waitcnt lgkmcnt(6)
  v_mfma_f32_16x16x32_bf16 v[36:39], v[164:167], v[68:71], v[36:39]
  s_waitcnt lgkmcnt(5)
  v_mfma_f32_16x16x32_bf16 v[36:39], v[168:171], v[72:75], v[36:39]
  s_waitcnt lgkmcnt(4)
  v_mfma_f32_16x16x32_bf16 v[36:39], v[172:175], v[76:79], v[36:39]
  s_waitcnt lgkmcnt(3)
  v_mfma_f32_16x16x32_bf16 v[36:39], v[176:179], v[80:83], v[36:39]
  s_waitcnt lgkmcnt(2)
  v_mfma_f32_16x16x32_bf16 v[36:39], v[180:183], v[84:87], v[36:39]
  s_waitcnt lgkmcnt(1)
  v_mfma_f32_16x16x32_bf16 v[36:39], v[184:187], v[88:91], v[36:39]
  s_waitcnt lgkmcnt(0)
  v_mfma_f32_16x16x32_bf16 v[36:39], v[188:191], v[92:95], v[36:39]
  ds_read_b128 v[160:163], v22 offset:512
  ds_read_b128 v[164:167], v22 offset:576
  ds_read_b128 v[168:171], v22 offset:640
  ds_read_b128 v[172:175], v22 offset:704
  ds_read_b128 v[176:179], v22 offset:768
  ds_read_b128 v[180:183], v22 offset:832
  ds_read_b128 v[184:187], v22 offset:896
  ds_read_b128 v[188:191], v22 offset:960
  s_waitcnt lgkmcnt(7)
  v_mfma_f32_16x16x32_bf16 v[36:39], v[160:163], v[96:99], v[36:39]
  s_waitcnt lgkmcnt(6)
  v_mfma_f32_16x16x32_bf16 v[36:39], v[164:167], v[100:103], v[36:39]
  s_waitcnt lgkmcnt(5)
  v_mfma_f32_16x16x32_bf16 v[36:39], v[168:171], v[104:107], v[36:39]
  s_waitcnt lgkmcnt(4)
  v_mfma_f32_16x16x32_bf16 v[36:39], v[172:175], v[108:111], v[36:39]
  s_waitcnt lgkmcnt(3)
  v_mfma_f32_16x16x32_bf16 v[36:39], v[176:179], v[112:115], v[36:39]
  s_waitcnt lgkmcnt(2)
  v_mfma_f32_16x16x32_bf16 v[36:39], v[180:183], v[116:119], v[36:39]
  s_waitcnt lgkmcnt(1)
  v_mfma_f32_16x16x32_bf16 v[36:39], v[184:187], v[120:123], v[36:39]
  s_waitcnt lgkmcnt(0)
  v_mfma_f32_16x16x32_bf16 v[36:39], v[188:191], v[124:127], v[36:39]
  s_nop 7
  s_nop 0
  v_max3_f32 v40, v36, v37, v38
  v_max_f32 v40, v40, v39
  ds_write_b32 v25, v40
  s_waitcnt lgkmcnt(0)
  s_barrier
  ds_read_b128 v[40:43], v27 offset:0
  ds_read_b128 v[44:47], v27 offset:16
  ds_read_b128 v[48:51], v27 offset:32
  ds_read_b128 v[52:55], v27 offset:48
  s_waitcnt lgkmcnt(0)
  v_max3_f32 v40, v40, v41, v42
  v_max_f32 v40, v40, v43
  v_max3_f32 v44, v44, v45, v46
  v_max_f32 v44, v44, v47
  v_max3_f32 v48, v48, v49, v50
  v_max_f32 v48, v48, v51
  v_max3_f32 v52, v52, v53, v54
  v_max_f32 v52, v52, v55
  v_max3_f32 v40, v40, v44, v48
  v_max_f32 v40, v40, v52
  v_mul_f32 v40, s82, v40
  v_max_f32 v40, v40, v32
  v_sub_f32 v41, v32, v40
  v_exp_f32 v41, v41
  v_mov_b32 v32, v40
  v_fma_f32 v44, v36, s82, -v40
  v_fma_f32 v45, v37, s82, -v40
  v_fma_f32 v46, v38, s82, -v40
  v_fma_f32 v47, v39, s82, -v40
  v_exp_f32 v44, v44
  v_exp_f32 v45, v45
  v_exp_f32 v46, v46
  v_exp_f32 v47, v47
  v_mul_f32 v33, v33, v41
  v_cvt_pk_bf16_f32 v48, v44, v45
  v_cvt_pk_bf16_f32 v49, v46, v47
  v_add_f32 v44, v44, v45
  v_add_f32 v46, v46, v47
  ds_write_b64 v28, v[48:49]
  ds_write_b32 v30, v41
  v_add_f32 v33, v33, v44
  v_add_f32 v33, v33, v46
  s_waitcnt lgkmcnt(0)
  s_barrier
  ds_read_b32 v240, v31 offset:0
  ds_read_b32 v241, v31 offset:64
  ds_read_b128 v[224:227], v29 offset:0
  ds_read_b128 v[228:231], v29 offset:64
  ds_read_b128 v[232:235], v29 offset:2560
  ds_read_b128 v[236:239], v29 offset:2624
  ds_read_b64_tr_b16 v[160:161], v24 offset:0
  ds_read_b64_tr_b16 v[162:163], v24 offset:16896
  ds_read_b64_tr_b16 v[164:165], v24 offset:32
  ds_read_b64_tr_b16 v[166:167], v24 offset:16928
  ds_read_b64_tr_b16 v[168:169], v24 offset:64
  ds_read_b64_tr_b16 v[170:171], v24 offset:16960
  ds_read_b64_tr_b16 v[172:173], v24 offset:96
  ds_read_b64_tr_b16 v[174:175], v24 offset:16992
  ds_read_b64_tr_b16 v[176:177], v24 offset:33792
  ds_read_b64_tr_b16 v[178:179], v24 offset:50688
  ds_read_b64_tr_b16 v[180:181], v24 offset:33824
  ds_read_b64_tr_b16 v[182:183], v24 offset:50720
  ds_read_b64_tr_b16 v[184:185], v24 offset:33856
  ds_read_b64_tr_b16 v[186:187], v24 offset:50752
  ds_read_b64_tr_b16 v[188:189], v24 offset:33888
  ds_read_b64_tr_b16 v[190:191], v24 offset:50784
  s_waitcnt lgkmcnt(15)
  v_mul_f32 v128, v128, v240
  v_mul_f32 v129, v129, v240
  v_mul_f32 v130, v130, v240
  v_mul_f32 v131, v131, v240
  v_mul_f32 v132, v132, v240
  v_mul_f32 v133, v133, v240
  v_mul_f32 v134, v134, v240
  v_mul_f32 v135, v135, v240
  v_mul_f32 v136, v136, v240
  v_mul_f32 v137, v137, v240
  v_mul_f32 v138, v138, v240
  v_mul_f32 v139, v139, v240
  v_mul_f32 v140, v140, v240
  v_mul_f32 v141, v141, v240
  v_mul_f32 v142, v142, v240
  v_mul_f32 v143, v143, v240
  v_mul_f32 v144, v144, v241
  v_mul_f32 v145, v145, v241
  v_mul_f32 v146, v146, v241
  v_mul_f32 v147, v147, v241
  v_mul_f32 v148, v148, v241
  v_mul_f32 v149, v149, v241
  v_mul_f32 v150, v150, v241
  v_mul_f32 v151, v151, v241
  v_mul_f32 v152, v152, v241
  v_mul_f32 v153, v153, v241
  v_mul_f32 v154, v154, v241
  v_mul_f32 v155, v155, v241
  v_mul_f32 v156, v156, v241
  v_mul_f32 v157, v157, v241
  v_mul_f32 v158, v158, v241
  v_mul_f32 v159, v159, v241
  s_waitcnt lgkmcnt(0)
  v_mfma_f32_16x16x32_bf16 v[128:131], v[160:163], v[224:227], v[128:131]
  v_mfma_f32_16x16x32_bf16 v[144:147], v[160:163], v[232:235], v[144:147]
  v_mfma_f32_16x16x32_bf16 v[132:135], v[164:167], v[224:227], v[132:135]
  v_mfma_f32_16x16x32_bf16 v[148:151], v[164:167], v[232:235], v[148:151]
  v_mfma_f32_16x16x32_bf16 v[136:139], v[168:171], v[224:227], v[136:139]
  v_mfma_f32_16x16x32_bf16 v[152:155], v[168:171], v[232:235], v[152:155]
  v_mfma_f32_16x16x32_bf16 v[140:143], v[172:175], v[224:227], v[140:143]
  v_mfma_f32_16x16x32_bf16 v[156:159], v[172:175], v[232:235], v[156:159]
  v_mfma_f32_16x16x32_bf16 v[128:131], v[176:179], v[228:231], v[128:131]
  v_mfma_f32_16x16x32_bf16 v[144:147], v[176:179], v[236:239], v[144:147]
  v_mfma_f32_16x16x32_bf16 v[132:135], v[180:183], v[228:231], v[132:135]
  v_mfma_f32_16x16x32_bf16 v[148:151], v[180:183], v[236:239], v[148:151]
  v_mfma_f32_16x16x32_bf16 v[136:139], v[184:187], v[228:231], v[136:139]
  v_mfma_f32_16x16x32_bf16 v[152:155], v[184:187], v[236:239], v[152:155]
  v_mfma_f32_16x16x32_bf16 v[140:143], v[188:191], v[228:231], v[140:143]
  v_mfma_f32_16x16x32_bf16 v[156:159], v[188:191], v[236:239], v[156:159]
  v_add_u32 v25, 2176, v25
  v_add_u32 v27, 2176, v27
  ds_write_b32 v25, v33
  v_mul_u32_u24 v34, 1040, v3
  v_lshl_add_u32 v34, v2, 3, v34
  s_lshl_b32 s66, s48, 7
  v_add_u32 v34, s66, v34
  s_lshl_b32 s66, s49, 20
  s_lshl_b32 s67, s50, 15
  s_add_u32 s66, s66, s67
  s_lshl_b32 s67, s48, 12
  s_add_u32 s66, s66, s67
  s_add_u32 s92, s42, s66
  s_addc_u32 s93, s43, 0
  s_add_u32 s92, s92, 2097152
  s_addc_u32 s93, s93, 0
  s_nop 7
  v_cvt_pk_bf16_f32 v160, v128, v129
  v_cvt_pk_bf16_f32 v161, v130, v131
  v_cvt_pk_bf16_f32 v162, v132, v133
  v_cvt_pk_bf16_f32 v163, v134, v135
  v_cvt_pk_bf16_f32 v164, v136, v137
  v_cvt_pk_bf16_f32 v165, v138, v139
  v_cvt_pk_bf16_f32 v166, v140, v141
  v_cvt_pk_bf16_f32 v167, v142, v143
  v_cvt_pk_bf16_f32 v168, v144, v145
  v_cvt_pk_bf16_f32 v169, v146, v147
  v_cvt_pk_bf16_f32 v170, v148, v149
  v_cvt_pk_bf16_f32 v171, v150, v151
  v_cvt_pk_bf16_f32 v172, v152, v153
  v_cvt_pk_bf16_f32 v173, v154, v155
  v_cvt_pk_bf16_f32 v174, v156, v157
  v_cvt_pk_bf16_f32 v175, v158, v159
  ds_write_b64 v34, v[160:161] offset:0
  ds_write_b64 v34, v[162:163] offset:32
  ds_write_b64 v34, v[164:165] offset:64
  ds_write_b64 v34, v[166:167] offset:96
  ds_write_b64 v34, v[168:169] offset:16640
  ds_write_b64 v34, v[170:171] offset:16672
  ds_write_b64 v34, v[172:173] offset:16704
  ds_write_b64 v34, v[174:175] offset:16736
  s_mul_i32 s66, s48, 4160
  v_add_u32 v34, s66, v20
  s_waitcnt lgkmcnt(0)
  s_barrier
  ds_read_b128 v[160:163], v34 offset:0
  ds_read_b128 v[164:167], v34 offset:1040
  ds_read_b128 v[168:171], v34 offset:2080
  ds_read_b128 v[172:175], v34 offset:3120
  s_waitcnt lgkmcnt(0)
  global_store_dwordx4 v20, v[160:163], s[92:93] offset:0 sc1
  global_store_dwordx4 v20, v[164:167], s[92:93] offset:1024 sc1
  global_store_dwordx4 v20, v[168:171], s[92:93] offset:2048 sc1
  global_store_dwordx4 v20, v[172:175], s[92:93] offset:3072 sc1
  s_cmp_eq_u32 s75, 0
  s_cbranch_scc0 L_sk_7
  ds_read_b128 v[40:43], v27 offset:0
  ds_read_b128 v[44:47], v27 offset:16
  ds_read_b128 v[48:51], v27 offset:32
  ds_read_b128 v[52:55], v27 offset:48
  s_waitcnt lgkmcnt(0)
  v_add_f32 v40, v40, v41
  v_add_f32 v40, v40, v42
  v_add_f32 v40, v40, v43
  v_add_f32 v40, v40, v44
  v_add_f32 v40, v40, v45
  v_add_f32 v40, v40, v46
  v_add_f32 v40, v40, v47
  v_add_f32 v40, v40, v48
  v_add_f32 v40, v40, v49
  v_add_f32 v40, v40, v50
  v_add_f32 v40, v40, v51
  v_add_f32 v40, v40, v52
  v_add_f32 v40, v40, v53
  v_add_f32 v40, v40, v54
  v_add_f32 v40, v40, v55
  v_mov_b32 v41, v40
  v_mov_b32 v40, v32
  v_lshlrev_b32 v35, 9, v26
  s_lshl_b32 s66, s49, 8
  s_lshl_b32 s67, s50, 3
  s_add_u32 s66, s66, s67
  s_add_u32 s92, s42, s66
  s_addc_u32 s93, s43, 0
  s_add_u32 s92, s92, 131072
  s_addc_u32 s93, s93, 0
  s_mov_b64 exec, 0xffff
  global_store_dwordx2 v35, v[40:41], s[92:93] sc1
  s_mov_b64 exec, -1
L_sk_7:
  s_waitcnt vmcnt(0)
  s_barrier
  s_cmp_eq_u32 s48, 0
  s_cbranch_scc0 L_sk_8
  s_mov_b64 exec, 1
  v_mov_b32 v12, 1
  global_atomic_add v12, v4, v12, s[40:41] offset:16 sc0 sc1
  s_waitcnt vmcnt(0)
  v_readfirstlane_b32 s66, v12
  s_mov_b64 exec, -1
  s_and_b32 s66, s66, 63
  s_cmp_eq_u32 s66, 63
  s_cbranch_scc0 L_nl_9
  s_add_u32 s90, s42, 999424
  s_addc_u32 s91, s43, 0
  v_lshlrev_b32 v12, 7, v1
  v_mov_b32 v13, 2
  global_store_dword v12, v13, s[90:91] sc1
L_nl_9:
L_sk_8:
  s_add_u32 s88, s24, s65
  s_addc_u32 s89, s25, 0
  global_load_dwordx4 v[192:195], v7, s[88:89] nt
  s_add_u32 s88, s88, 8192
  s_addc_u32 s89, s89, 0
  global_load_dwordx4 v[196:199], v7, s[88:89] nt
  s_add_u32 s88, s88, 8192
  s_addc_u32 s89, s89, 0
  global_load_dwordx4 v[200:203], v7, s[88:89] nt
  s_add_u32 s88, s88, 8192
  s_addc_u32 s89, s89, 0
  global_load_dwordx4 v[204:207], v7, s[88:89] nt
  s_add_u32 s88, s88, 8192
  s_addc_u32 s89, s89, 0
  global_load_dwordx4 v[208:211], v7, s[88:89] nt
  s_add_u32 s88, s88, 8192
  s_addc_u32 s89, s89, 0
  global_load_dwordx4 v[212:215], v7, s[88:89] nt
  s_add_u32 s88, s88, 8192
  s_addc_u32 s89, s89, 0
  global_load_dwordx4 v[216:219], v7, s[88:89] nt
  s_add_u32 s88, s88, 8192
  s_addc_u32 s89, s89, 0
  global_load_dwordx4 v[220:223], v7, s[88:89] nt
  s_lshl_b32 s66, s44, 17
  s_lshl_b32 s67, s45, 16
  s_add_u32 s66, s66, s67
  s_lshl_b32 s67, s48, 7
  s_add_u32 s66, s66, s67
  s_add_u32 s88, s26, s66
  s_addc_u32 s89, s27, 0
  s_add_u32 s88, s88, 4096
  s_addc_u32 s89, s89, 0
  v_lshlrev_b32 v12, 13, v5
  v_lshl_add_u32 v12, v6, 4, v12
  global_load_dwordx4 v[96:99], v12, s[88:89] offset:-4096 nt
  global_load_dwordx4 v[100:103], v12, s[88:89] offset:-3072 nt
  global_load_dwordx4 v[104:107], v12, s[88:89] offset:-2048 nt
  global_load_dwordx4 v[108:111], v12, s[88:89] offset:-1024 nt
  global_load_dwordx4 v[112:115], v12, s[88:89] offset:0 nt
  global_load_dwordx4 v[116:119], v12, s[88:89] offset:1024 nt
  global_load_dwordx4 v[120:123], v12, s[88:89] offset:2048 nt
  global_load_dwordx4 v[124:127], v12, s[88:89] offset:3072 nt
  s_lshl_b32 s66, s44, 17
  s_add_u32 s60, s36, s66
  s_addc_u32 s61, s37, 0
  s_and_b32 s61, s61, 0xffff
  s_mov_b32 s62, 0x20000
  s_mov_b32 s63, 0x20000
  s_lshl_b32 s67, s48, 14
  s_mul_i32 s68, s48, 16896
  s_mov_b32 m0, s68
  s_add_u32 s68, s68, 1056
  buffer_load_dwordx4 v20, s[60:63], s67 offen nt lds
  s_add_u32 s67, s67, 1024
  s_mov_b32 m0, s68
  s_add_u32 s68, s68, 1056
  buffer_load_dwordx4 v20, s[60:63], s67 offen nt lds
  s_add_u32 s67, s67, 1024
  s_mov_b32 m0, s68
  s_add_u32 s68, s68, 1056
  buffer_load_dwordx4 v20, s[60:63], s67 offen nt lds
  s_add_u32 s67, s67, 1024
  s_mov_b32 m0, s68
  s_add_u32 s68, s68, 1056
  buffer_load_dwordx4 v20, s[60:63], s67 offen nt lds
  s_add_u32 s67, s67, 1024
  s_mov_b32 m0, s68
  s_add_u32 s68, s68, 1056
  buffer_load_dwordx4 v20, s[60:63], s67 offen nt lds
  s_add_u32 s67, s67, 1024
  s_mov_b32 m0, s68
  s_add_u32 s68, s68, 1056
  buffer_load_dwordx4 v20, s[60:63], s67 offen nt lds
  s_add_u32 s67, s67, 1024
  s_mov_b32 m0, s68
  s_add_u32 s68, s68, 1056
  buffer_load_dwordx4 v20, s[60:63], s67 offen nt lds
  s_add_u32 s67, s67, 1024
  s_mov_b32 m0, s68
  s_add_u32 s68, s68, 1056
  buffer_load_dwordx4 v20, s[60:63], s67 offen nt lds
  s_add_u32 s67, s67, 1024
  s_mov_b32 m0, s68
  s_add_u32 s68, s68, 1056
  buffer_load_dwordx4 v20, s[60:63], s67 offen nt lds
  s_add_u32 s67, s67, 1024
  s_mov_b32 m0, s68
  s_add_u32 s68, s68, 1056
  buffer_load_dwordx4 v20, s[60:63], s67 offen nt lds
  s_add_u32 s67, s67, 1024
  s_mov_b32 m0, s68
  s_add_u32 s68, s68, 1056
  buffer_load_dwordx4 v20, s[60:63], s67 offen nt lds
  s_add_u32 s67, s67, 1024
  s_mov_b32 m0, s68
  s_add_u32 s68, s68, 1056
  buffer_load_dwordx4 v20, s[60:63], s67 offen nt lds
  s_add_u32 s67, s67, 1024
  s_mov_b32 m0, s68
  s_add_u32 s68, s68, 1056
  buffer_load_dwordx4 v20, s[60:63], s67 offen nt lds
  s_add_u32 s67, s67, 1024
  s_mov_b32 m0, s68
  s_add_u32 s68, s68, 1056
  buffer_load_dwordx4 v20, s[60:63], s67 offen nt lds
  s_add_u32 s67, s67, 1024
  s_mov_b32 m0, s68
  s_add_u32 s68, s68, 1056
  buffer_load_dwordx4 v20, s[60:63], s67 offen nt lds
  s_add_u32 s67, s67, 1024
  s_mov_b32 m0, s68
  s_add_u32 s68, s68, 1056
  buffer_load_dwordx4 v20, s[60:63], s67 offen nt lds
  s_add_u32 s67, s67, 1024
  s_cmp_eq_u32 s48, 0
  s_cbranch_scc0 L_sk_10
  s_lshl_b32 s66, s2, 7
  s_add_u32 s90, s42, s66
  s_addc_u32 s91, s43, 0
  s_add_u32 s90, s90, 999424
  s_addc_u32 s91, s91, 0
  s_mov_b32 s79, 0
L_poll_11:
  global_load_dword v12, v4, s[90:91] offset:0 sc1
  s_waitcnt vmcnt(0)
  v_readfirstlane_b32 s66, v12
  s_cmp_ge_u32 s66, 2
  s_cbranch_scc1 L_polld_12
  s_sleep 1
  s_add_u32 s79, s79, 1
  s_cmp_lt_u32 s79, 0x20000
  s_cbranch_scc1 L_poll_11
L_polld_12:
  s_lshl_b32 s66, s45, 2
  s_add_u32 s90, s40, s66
  s_addc_u32 s91, s41, 0
  s_add_u32 s90, s90, 64
  s_addc_u32 s91, s91, 0
  s_mov_b32 s79, 0
L_lq_13:
  global_load_dword v22, v4, s[90:91] sc1
  s_waitcnt vmcnt(0)
  v_readfirstlane_b32 s66, v22
  s_lshr_b32 s66, s66, s44
  s_and_b32 s66, s66, 1
  s_cmp_eq_u32 s66, 1
  s_cbranch_scc1 L_lqd_14
  s_sleep 2
  s_add_u32 s79, s79, 1
  s_cmp_lt_u32 s79, 0x20000
  s_cbranch_scc1 L_lq_13
L_lqd_14:
L_sk_10:
  s_barrier
  s_lshl_b32 s66, s44, 9
  s_lshl_b32 s67, s45, 8
  s_add_u32 s66, s66, s67
  s_add_u32 s90, s42, s66
  s_addc_u32 s91, s43, 0
  v_lshlrev_b32 v22, 4, v3
  global_load_dwordx4 v[224:227], v22, s[90:91] sc1
  v_lshlrev_b32 v13, 3, v1
  s_lshl_b32 s66, s44, 9
  s_add_u32 s92, s42, s66
  s_addc_u32 s93, s43, 0
  s_add_u32 s92, s92, 131072
  s_addc_u32 s93, s93, 0
  global_load_dwordx2 v[16:17], v13, s[92:93] sc1
  s_lshr_b32 s66, s48, 2
  s_lshl_b32 s67, s66, 20
  s_and_b32 s68, s48, 3
  s_lshl_b32 s68, s68, 8
  s_add_u32 s67, s67, s68
  s_lshl_b32 s68, s44, 10
  s_add_u32 s67, s67, s68
  s_add_u32 s92, s42, s67
  s_addc_u32 s93, s43, 0
  s_add_u32 s92, s92, 2097152
  s_addc_u32 s93, s93, 0
  v_lshlrev_b32 v14, 2, v1
  global_load_dword v128, v14, s[92:93] sc1
  s_add_u32 s92, s92, 32768
  s_addc_u32 s93, s93, 0
  global_load_dword v129, v14, s[92:93] sc1
  s_add_u32 s92, s92, 32768
  s_addc_u32 s93, s93, 0
  global_load_dword v130, v14, s[92:93] sc1
  s_add_u32 s92, s92, 32768
  s_addc_u32 s93, s93, 0
  global_load_dword v131, v14, s[92:93] sc1
  s_add_u32 s92, s92, 32768
  s_addc_u32 s93, s93, 0
  global_load_dword v132, v14, s[92:93] sc1
  s_add_u32 s92, s92, 32768
  s_addc_u32 s93, s93, 0
  global_load_dword v133, v14, s[92:93] sc1
  s_add_u32 s92, s92, 32768
  s_addc_u32 s93, s93, 0
  global_load_dword v134, v14, s[92:93] sc1
  s_add_u32 s92, s92, 32768
  s_addc_u32 s93, s93, 0
  global_load_dword v135, v14, s[92:93] sc1
  s_add_u32 s92, s92, 32768
  s_addc_u32 s93, s93, 0
  global_load_dword v136, v14, s[92:93] sc1
  s_add_u32 s92, s92, 32768
  s_addc_u32 s93, s93, 0
  global_load_dword v137, v14, s[92:93] sc1
  s_add_u32 s92, s92, 32768
  s_addc_u32 s93, s93, 0
  global_load_dword v138, v14, s[92:93] sc1
  s_add_u32 s92, s92, 32768
  s_addc_u32 s93, s93, 0
  global_load_dword v139, v14, s[92:93] sc1
  s_add_u32 s92, s92, 32768
  s_addc_u32 s93, s93, 0
  global_load_dword v140, v14, s[92:93] sc1
  s_add_u32 s92, s92, 32768
  s_addc_u32 s93, s93, 0
  global_load_dword v141, v14, s[92:93] sc1
  s_add_u32 s92, s92, 32768
  s_addc_u32 s93, s93, 0
  global_load_dword v142, v14, s[92:93] sc1
  s_add_u32 s92, s92, 32768
  s_addc_u32 s93, s93, 0
  global_load_dword v143, v14, s[92:93] sc1
  s_add_u32 s92, s92, 32768
  s_addc_u32 s93, s93, 0
  global_load_dword v144, v14, s[92:93] sc1
  s_add_u32 s92, s92, 32768
  s_addc_u32 s93, s93, 0
  global_load_dword v145, v14, s[92:93] sc1
  s_add_u32 s92, s92, 32768
  s_addc_u32 s93, s93, 0
  global_load_dword v146, v14, s[92:93] sc1
  s_add_u32 s92, s92, 32768
  s_addc_u32 s93, s93, 0
  global_load_dword v147, v14, s[92:93] sc1
  s_add_u32 s92, s92, 32768
  s_addc_u32 s93, s93, 0
  global_load_dword v148, v14, s[92:93] sc1
  s_add_u32 s92, s92, 32768
  s_addc_u32 s93, s93, 0
  global_load_dword v149, v14, s[92:93] sc1
  s_add_u32 s92, s92, 32768
  s_addc_u32 s93, s93, 0
  global_load_dword v150, v14, s[92:93] sc1
  s_add_u32 s92, s92, 32768
  s_addc_u32 s93, s93, 0
  global_load_dword v151, v14, s[92:93] sc1
  s_add_u32 s92, s92, 32768
  s_addc_u32 s93, s93, 0
  global_load_dword v152, v14, s[92:93] sc1
  s_add_u32 s92, s92, 32768
  s_addc_u32 s93, s93, 0
  global_load_dword v153, v14, s[92:93] sc1
  s_add_u32 s92, s92, 32768
  s_addc_u32 s93, s93, 0
  global_load_dword v154, v14, s[92:93] sc1
  s_add_u32 s92, s92, 32768
  s_addc_u32 s93, s93, 0
  global_load_dword v155, v14, s[92:93] sc1
  s_add_u32 s92, s92, 32768
  s_addc_u32 s93, s93, 0
  global_load_dword v156, v14, s[92:93] sc1
  s_add_u32 s92, s92, 32768
  s_addc_u32 s93, s93, 0
  global_load_dword v157, v14, s[92:93] sc1
  s_add_u32 s92, s92, 32768
  s_addc_u32 s93, s93, 0
  global_load_dword v158, v14, s[92:93] sc1
  s_add_u32 s92, s92, 32768
  s_addc_u32 s93, s93, 0
  global_load_dword v159, v14, s[92:93] sc1
  s_waitcnt vmcnt(32)
  v_mov_b32 v18, v16
  s_nop 1
  v_max_f32_dpp v18, v18, v18 row_ror:8 row_mask:0xf bank_mask:0xf
  s_nop 1
  v_max_f32_dpp v18, v18, v18 row_ror:4 row_mask:0xf bank_mask:0xf
  s_nop 1
  v_max_f32_dpp v18, v18, v18 row_ror:2 row_mask:0xf bank_mask:0xf
  s_nop 1
  v_max_f32_dpp v18, v18, v18 row_ror:1 row_mask:0xf bank_mask:0xf
  ds_swizzle_b32 v19, v18 offset:0x401F
  s_waitcnt lgkmcnt(0)
  v_max_f32 v18, v18, v19
  v_sub_f32 v16, v16, v18
  v_exp_f32 v16, v16
  s_nop 0
  v_mul_f32 v17, v17, v16
  v_mov_b32 v18, v17
  s_nop 1
  v_add_f32_dpp v18, v18, v18 row_ror:8 row_mask:0xf bank_mask:0xf
  s_nop 1
  v_add_f32_dpp v18, v18, v18 row_ror:4 row_mask:0xf bank_mask:0xf
  s_nop 1
  v_add_f32_dpp v18, v18, v18 row_ror:2 row_mask:0xf bank_mask:0xf
  s_nop 1
  v_add_f32_dpp v18, v18, v18 row_ror:1 row_mask:0xf bank_mask:0xf
  ds_swizzle_b32 v19, v18 offset:0x401F
  s_waitcnt lgkmcnt(0)
  v_add_f32 v18, v18, v19
  v_rcp_f32 v18, v18
  s_nop 0
  v_mul_f32 v16, v16, v18
  v_mov_b32 v20, 0
  v_mov_b32 v21, 0
  s_lshl_b32 s66, s66, 5
  s_add_u32 s67, s66, 0
  v_readlane_b32 s68, v16, s67
  s_add_u32 s67, s66, 1
  v_readlane_b32 s69, v16, s67
  s_add_u32 s67, s66, 2
  v_readlane_b32 s70, v16, s67
  s_add_u32 s67, s66, 3
  v_readlane_b32 s71, v16, s67
  s_add_u32 s67, s66, 4
  v_readlane_b32 s72, v16, s67
  s_add_u32 s67, s66, 5
  v_readlane_b32 s73, v16, s67
  s_add_u32 s67, s66, 6
  v_readlane_b32 s74, v16, s67
  s_add_u32 s67, s66, 7
  v_readlane_b32 s75, v16, s67
  s_waitcnt vmcnt(24)
  v_lshlrev_b32 v22, 16, v128
  v_and_b32 v23, 0xffff0000, v128
  v_fmac_f32 v20, s68, v22
  v_fmac_f32 v21, s68, v23
  v_lshlrev_b32 v22, 16, v129
  v_and_b32 v23, 0xffff0000, v129
  v_fmac_f32 v20, s69, v22
  v_fmac_f32 v21, s69, v23
  v_lshlrev_b32 v22, 16, v130
  v_and_b32 v23, 0xffff0000, v130
  v_fmac_f32 v20, s70, v22
  v_fmac_f32 v21, s70, v23
  v_lshlrev_b32 v22, 16, v131
  v_and_b32 v23, 0xffff0000, v131
  v_fmac_f32 v20, s71, v22
  v_fmac_f32 v21, s71, v23
  v_lshlrev_b32 v22, 16, v132
  v_and_b32 v23, 0xffff0000, v132
  v_fmac_f32 v20, s72, v22
  v_fmac_f32 v21, s72, v23
  v_lshlrev_b32 v22, 16, v133
  v_and_b32 v23, 0xffff0000, v133
  v_fmac_f32 v20, s73, v22
  v_fmac_f32 v21, s73, v23
  v_lshlrev_b32 v22, 16, v134
  v_and_b32 v23, 0xffff0000, v134
  v_fmac_f32 v20, s74, v22
  v_fmac_f32 v21, s74, v23
  v_lshlrev_b32 v22, 16, v135
  v_and_b32 v23, 0xffff0000, v135
  v_fmac_f32 v20, s75, v22
  v_fmac_f32 v21, s75, v23
  s_add_u32 s67, s66, 8
  v_readlane_b32 s68, v16, s67
  s_add_u32 s67, s66, 9
  v_readlane_b32 s69, v16, s67
  s_add_u32 s67, s66, 10
  v_readlane_b32 s70, v16, s67
  s_add_u32 s67, s66, 11
  v_readlane_b32 s71, v16, s67
  s_add_u32 s67, s66, 12
  v_readlane_b32 s72, v16, s67
  s_add_u32 s67, s66, 13
  v_readlane_b32 s73, v16, s67
  s_add_u32 s67, s66, 14
  v_readlane_b32 s74, v16, s67
  s_add_u32 s67, s66, 15
  v_readlane_b32 s75, v16, s67
  s_waitcnt vmcnt(16)
  v_lshlrev_b32 v22, 16, v136
  v_and_b32 v23, 0xffff0000, v136
  v_fmac_f32 v20, s68, v22
  v_fmac_f32 v21, s68, v23
  v_lshlrev_b32 v22, 16, v137
  v_and_b32 v23, 0xffff0000, v137
  v_fmac_f32 v20, s69, v22
  v_fmac_f32 v21, s69, v23
  v_lshlrev_b32 v22, 16, v138
  v_and_b32 v23, 0xffff0000, v138
  v_fmac_f32 v20, s70, v22
  v_fmac_f32 v21, s70, v23
  v_lshlrev_b32 v22, 16, v139
  v_and_b32 v23, 0xffff0000, v139
  v_fmac_f32 v20, s71, v22
  v_fmac_f32 v21, s71, v23
  v_lshlrev_b32 v22, 16, v140
  v_and_b32 v23, 0xffff0000, v140
  v_fmac_f32 v20, s72, v22
  v_fmac_f32 v21, s72, v23
  v_lshlrev_b32 v22, 16, v141
  v_and_b32 v23, 0xffff0000, v141
  v_fmac_f32 v20, s73, v22
  v_fmac_f32 v21, s73, v23
  v_lshlrev_b32 v22, 16, v142
  v_and_b32 v23, 0xffff0000, v142
  v_fmac_f32 v20, s74, v22
  v_fmac_f32 v21, s74, v23
  v_lshlrev_b32 v22, 16, v143
  v_and_b32 v23, 0xffff0000, v143
  v_fmac_f32 v20, s75, v22
  v_fmac_f32 v21, s75, v23
  s_add_u32 s67, s66, 16
  v_readlane_b32 s68, v16, s67
  s_add_u32 s67, s66, 17
  v_readlane_b32 s69, v16, s67
  s_add_u32 s67, s66, 18
  v_readlane_b32 s70, v16, s67
  s_add_u32 s67, s66, 19
  v_readlane_b32 s71, v16, s67
  s_add_u32 s67, s66, 20
  v_readlane_b32 s72, v16, s67
  s_add_u32 s67, s66, 21
  v_readlane_b32 s73, v16, s67
  s_add_u32 s67, s66, 22
  v_readlane_b32 s74, v16, s67
  s_add_u32 s67, s66, 23
  v_readlane_b32 s75, v16, s67
  s_waitcnt vmcnt(8)
  v_lshlrev_b32 v22, 16, v144
  v_and_b32 v23, 0xffff0000, v144
  v_fmac_f32 v20, s68, v22
  v_fmac_f32 v21, s68, v23
  v_lshlrev_b32 v22, 16, v145
  v_and_b32 v23, 0xffff0000, v145
  v_fmac_f32 v20, s69, v22
  v_fmac_f32 v21, s69, v23
  v_lshlrev_b32 v22, 16, v146
  v_and_b32 v23, 0xffff0000, v146
  v_fmac_f32 v20, s70, v22
  v_fmac_f32 v21, s70, v23
  v_lshlrev_b32 v22, 16, v147
  v_and_b32 v23, 0xffff0000, v147
  v_fmac_f32 v20, s71, v22
  v_fmac_f32 v21, s71, v23
  v_lshlrev_b32 v22, 16, v148
  v_and_b32 v23, 0xffff0000, v148
  v_fmac_f32 v20, s72, v22
  v_fmac_f32 v21, s72, v23
  v_lshlrev_b32 v22, 16, v149
  v_and_b32 v23, 0xffff0000, v149
  v_fmac_f32 v20, s73, v22
  v_fmac_f32 v21, s73, v23
  v_lshlrev_b32 v22, 16, v150
  v_and_b32 v23, 0xffff0000, v150
  v_fmac_f32 v20, s74, v22
  v_fmac_f32 v21, s74, v23
  v_lshlrev_b32 v22, 16, v151
  v_and_b32 v23, 0xffff0000, v151
  v_fmac_f32 v20, s75, v22
  v_fmac_f32 v21, s75, v23
  s_add_u32 s67, s66, 24
  v_readlane_b32 s68, v16, s67
  s_add_u32 s67, s66, 25
  v_readlane_b32 s69, v16, s67
  s_add_u32 s67, s66, 26
  v_readlane_b32 s70, v16, s67
  s_add_u32 s67, s66, 27
  v_readlane_b32 s71, v16, s67
  s_add_u32 s67, s66, 28
  v_readlane_b32 s72, v16, s67
  s_add_u32 s67, s66, 29
  v_readlane_b32 s73, v16, s67
  s_add_u32 s67, s66, 30
  v_readlane_b32 s74, v16, s67
  s_add_u32 s67, s66, 31
  v_readlane_b32 s75, v16, s67
  s_waitcnt vmcnt(0)
  v_lshlrev_b32 v22, 16, v152
  v_and_b32 v23, 0xffff0000, v152
  v_fmac_f32 v20, s68, v22
  v_fmac_f32 v21, s68, v23
  v_lshlrev_b32 v22, 16, v153
  v_and_b32 v23, 0xffff0000, v153
  v_fmac_f32 v20, s69, v22
  v_fmac_f32 v21, s69, v23
  v_lshlrev_b32 v22, 16, v154
  v_and_b32 v23, 0xffff0000, v154
  v_fmac_f32 v20, s70, v22
  v_fmac_f32 v21, s70, v23
  v_lshlrev_b32 v22, 16, v155
  v_and_b32 v23, 0xffff0000, v155
  v_fmac_f32 v20, s71, v22
  v_fmac_f32 v21, s71, v23
  v_lshlrev_b32 v22, 16, v156
  v_and_b32 v23, 0xffff0000, v156
  v_fmac_f32 v20, s72, v22
  v_fmac_f32 v21, s72, v23
  v_lshlrev_b32 v22, 16, v157
  v_and_b32 v23, 0xffff0000, v157
  v_fmac_f32 v20, s73, v22
  v_fmac_f32 v21, s73, v23
  v_lshlrev_b32 v22, 16, v158
  v_and_b32 v23, 0xffff0000, v158
  v_fmac_f32 v20, s74, v22
  v_fmac_f32 v21, s74, v23
  v_lshlrev_b32 v22, 16, v159
  v_and_b32 v23, 0xffff0000, v159
  v_fmac_f32 v20, s75, v22
  v_fmac_f32 v21, s75, v23
  s_lshl_b32 s66, s48, 9
  s_add_u32 s66, s66, 149120
  v_add_u32 v12, s66, v13
  ds_write_b64 v12, v[20:21]
  s_waitcnt lgkmcnt(0)
  s_barrier
  s_lshl_b32 s66, s48, 8
  s_add_u32 s66, s66, 149120
  v_lshlrev_b32 v12, 5, v5
  v_add_u32 v12, s66, v12
  ds_read_b128 v[16:19], v12 offset:0
  ds_read_b128 v[20:23], v12 offset:16
  ds_read_b128 v[24:27], v12 offset:2048
  ds_read_b128 v[28:31], v12 offset:2064
  v_mov_b32 v240, 0
  v_mov_b32 v241, 0
  v_mov_b32 v242, 0
  v_mov_b32 v243, 0
  v_mov_b32 v244, 0
  v_mov_b32 v245, 0
  v_mov_b32 v246, 0
  v_mov_b32 v247, 0
  v_mov_b32 v248, 0
  v_mov_b32 v249, 0
  v_mov_b32 v250, 0
  v_mov_b32 v251, 0
  v_mov_b32 v252, 0
  v_mov_b32 v253, 0
  v_mov_b32 v254, 0
  v_mov_b32 v255, 0
  s_waitcnt lgkmcnt(0)
  v_lshlrev_b32 v12, 16, v192
  v_and_b32 v13, 0xffff0000, v192
  v_fmac_f32 v240, v16, v12
  v_fmac_f32 v241, v16, v13
  v_fmac_f32 v248, v24, v12
  v_fmac_f32 v249, v24, v13
  v_lshlrev_b32 v12, 16, v193
  v_and_b32 v13, 0xffff0000, v193
  v_fmac_f32 v242, v16, v12
  v_fmac_f32 v243, v16, v13
  v_fmac_f32 v250, v24, v12
  v_fmac_f32 v251, v24, v13
  v_lshlrev_b32 v12, 16, v194
  v_and_b32 v13, 0xffff0000, v194
  v_fmac_f32 v244, v16, v12
  v_fmac_f32 v245, v16, v13
  v_fmac_f32 v252, v24, v12
  v_fmac_f32 v253, v24, v13
  v_lshlrev_b32 v12, 16, v195
  v_and_b32 v13, 0xffff0000, v195
  v_fmac_f32 v246, v16, v12
  v_fmac_f32 v247, v16, v13
  v_fmac_f32 v254, v24, v12
  v_fmac_f32 v255, v24, v13
  v_lshlrev_b32 v12, 16, v196
  v_and_b32 v13, 0xffff0000, v196
  v_fmac_f32 v240, v17, v12
  v_fmac_f32 v241, v17, v13
  v_fmac_f32 v248, v25, v12
  v_fmac_f32 v249, v25, v13
  v_lshlrev_b32 v12, 16, v197
  v_and_b32 v13, 0xffff0000, v197
  v_fmac_f32 v242, v17, v12
  v_fmac_f32 v243, v17, v13
  v_fmac_f32 v250, v25, v12
  v_fmac_f32 v251, v25, v13
  v_lshlrev_b32 v12, 16, v198
  v_and_b32 v13, 0xffff0000, v198
  v_fmac_f32 v244, v17, v12
  v_fmac_f32 v245, v17, v13
  v_fmac_f32 v252, v25, v12
  v_fmac_f32 v253, v25, v13
  v_lshlrev_b32 v12, 16, v199
  v_and_b32 v13, 0xffff0000, v199
  v_fmac_f32 v246, v17, v12
  v_fmac_f32 v247, v17, v13
  v_fmac_f32 v254, v25, v12
  v_fmac_f32 v255, v25, v13
  v_lshlrev_b32 v12, 16, v200
  v_and_b32 v13, 0xffff0000, v200
  v_fmac_f32 v240, v18, v12
  v_fmac_f32 v241, v18, v13
  v_fmac_f32 v248, v26, v12
  v_fmac_f32 v249, v26, v13
  v_lshlrev_b32 v12, 16, v201
  v_and_b32 v13, 0xffff0000, v201
  v_fmac_f32 v242, v18, v12
  v_fmac_f32 v243, v18, v13
  v_fmac_f32 v250, v26, v12
  v_fmac_f32 v251, v26, v13
  v_lshlrev_b32 v12, 16, v202
  v_and_b32 v13, 0xffff0000, v202
  v_fmac_f32 v244, v18, v12
  v_fmac_f32 v245, v18, v13
  v_fmac_f32 v252, v26, v12
  v_fmac_f32 v253, v26, v13
  v_lshlrev_b32 v12, 16, v203
  v_and_b32 v13, 0xffff0000, v203
  v_fmac_f32 v246, v18, v12
  v_fmac_f32 v247, v18, v13
  v_fmac_f32 v254, v26, v12
  v_fmac_f32 v255, v26, v13
  v_lshlrev_b32 v12, 16, v204
  v_and_b32 v13, 0xffff0000, v204
  v_fmac_f32 v240, v19, v12
  v_fmac_f32 v241, v19, v13
  v_fmac_f32 v248, v27, v12
  v_fmac_f32 v249, v27, v13
  v_lshlrev_b32 v12, 16, v205
  v_and_b32 v13, 0xffff0000, v205
  v_fmac_f32 v242, v19, v12
  v_fmac_f32 v243, v19, v13
  v_fmac_f32 v250, v27, v12
  v_fmac_f32 v251, v27, v13
  v_lshlrev_b32 v12, 16, v206
  v_and_b32 v13, 0xffff0000, v206
  v_fmac_f32 v244, v19, v12
  v_fmac_f32 v245, v19, v13
  v_fmac_f32 v252, v27, v12
  v_fmac_f32 v253, v27, v13
  v_lshlrev_b32 v12, 16, v207
  v_and_b32 v13, 0xffff0000, v207
  v_fmac_f32 v246, v19, v12
  v_fmac_f32 v247, v19, v13
  v_fmac_f32 v254, v27, v12
  v_fmac_f32 v255, v27, v13
  v_lshlrev_b32 v12, 16, v208
  v_and_b32 v13, 0xffff0000, v208
  v_fmac_f32 v240, v20, v12
  v_fmac_f32 v241, v20, v13
  v_fmac_f32 v248, v28, v12
  v_fmac_f32 v249, v28, v13
  v_lshlrev_b32 v12, 16, v209
  v_and_b32 v13, 0xffff0000, v209
  v_fmac_f32 v242, v20, v12
  v_fmac_f32 v243, v20, v13
  v_fmac_f32 v250, v28, v12
  v_fmac_f32 v251, v28, v13
  v_lshlrev_b32 v12, 16, v210
  v_and_b32 v13, 0xffff0000, v210
  v_fmac_f32 v244, v20, v12
  v_fmac_f32 v245, v20, v13
  v_fmac_f32 v252, v28, v12
  v_fmac_f32 v253, v28, v13
  v_lshlrev_b32 v12, 16, v211
  v_and_b32 v13, 0xffff0000, v211
  v_fmac_f32 v246, v20, v12
  v_fmac_f32 v247, v20, v13
  v_fmac_f32 v254, v28, v12
  v_fmac_f32 v255, v28, v13
  v_lshlrev_b32 v12, 16, v212
  v_and_b32 v13, 0xffff0000, v212
  v_fmac_f32 v240, v21, v12
  v_fmac_f32 v241, v21, v13
  v_fmac_f32 v248, v29, v12
  v_fmac_f32 v249, v29, v13
  v_lshlrev_b32 v12, 16, v213
  v_and_b32 v13, 0xffff0000, v213
  v_fmac_f32 v242, v21, v12
  v_fmac_f32 v243, v21, v13
  v_fmac_f32 v250, v29, v12
  v_fmac_f32 v251, v29, v13
  v_lshlrev_b32 v12, 16, v214
  v_and_b32 v13, 0xffff0000, v214
  v_fmac_f32 v244, v21, v12
  v_fmac_f32 v245, v21, v13
  v_fmac_f32 v252, v29, v12
  v_fmac_f32 v253, v29, v13
  v_lshlrev_b32 v12, 16, v215
  v_and_b32 v13, 0xffff0000, v215
  v_fmac_f32 v246, v21, v12
  v_fmac_f32 v247, v21, v13
  v_fmac_f32 v254, v29, v12
  v_fmac_f32 v255, v29, v13
  v_lshlrev_b32 v12, 16, v216
  v_and_b32 v13, 0xffff0000, v216
  v_fmac_f32 v240, v22, v12
  v_fmac_f32 v241, v22, v13
  v_fmac_f32 v248, v30, v12
  v_fmac_f32 v249, v30, v13
  v_lshlrev_b32 v12, 16, v217
  v_and_b32 v13, 0xffff0000, v217
  v_fmac_f32 v242, v22, v12
  v_fmac_f32 v243, v22, v13
  v_fmac_f32 v250, v30, v12
  v_fmac_f32 v251, v30, v13
  v_lshlrev_b32 v12, 16, v218
  v_and_b32 v13, 0xffff0000, v218
  v_fmac_f32 v244, v22, v12
  v_fmac_f32 v245, v22, v13
  v_fmac_f32 v252, v30, v12
  v_fmac_f32 v253, v30, v13
  v_lshlrev_b32 v12, 16, v219
  v_and_b32 v13, 0xffff0000, v219
  v_fmac_f32 v246, v22, v12
  v_fmac_f32 v247, v22, v13
  v_fmac_f32 v254, v30, v12
  v_fmac_f32 v255, v30, v13
  v_lshlrev_b32 v12, 16, v220
  v_and_b32 v13, 0xffff0000, v220
  v_fmac_f32 v240, v23, v12
  v_fmac_f32 v241, v23, v13
  v_fmac_f32 v248, v31, v12
  v_fmac_f32 v249, v31, v13
  v_lshlrev_b32 v12, 16, v221
  v_and_b32 v13, 0xffff0000, v221
  v_fmac_f32 v242, v23, v12
  v_fmac_f32 v243, v23, v13
  v_fmac_f32 v250, v31, v12
  v_fmac_f32 v251, v31, v13
  v_lshlrev_b32 v12, 16, v222
  v_and_b32 v13, 0xffff0000, v222
  v_fmac_f32 v244, v23, v12
  v_fmac_f32 v245, v23, v13
  v_fmac_f32 v252, v31, v12
  v_fmac_f32 v253, v31, v13
  v_lshlrev_b32 v12, 16, v223
  v_and_b32 v13, 0xffff0000, v223
  v_fmac_f32 v246, v23, v12
  v_fmac_f32 v247, v23, v13
  v_fmac_f32 v254, v31, v12
  v_fmac_f32 v255, v31, v13
  ds_swizzle_b32 v176, v240 offset:0x201f
  ds_swizzle_b32 v177, v241 offset:0x201f
  ds_swizzle_b32 v178, v242 offset:0x201f
  ds_swizzle_b32 v179, v243 offset:0x201f
  ds_swizzle_b32 v180, v244 offset:0x201f
  ds_swizzle_b32 v181, v245 offset:0x201f
  ds_swizzle_b32 v182, v246 offset:0x201f
  ds_swizzle_b32 v183, v247 offset:0x201f
  ds_swizzle_b32 v184, v248 offset:0x201f
  ds_swizzle_b32 v185, v249 offset:0x201f
  ds_swizzle_b32 v186, v250 offset:0x201f
  ds_swizzle_b32 v187, v251 offset:0x201f
  ds_swizzle_b32 v188, v252 offset:0x201f
  ds_swizzle_b32 v189, v253 offset:0x201f
  ds_swizzle_b32 v190, v254 offset:0x201f
  ds_swizzle_b32 v191, v255 offset:0x201f
  s_waitcnt lgkmcnt(0)
  v_add_f32 v240, v240, v176
  v_add_f32 v241, v241, v177
  v_add_f32 v242, v242, v178
  v_add_f32 v243, v243, v179
  v_add_f32 v244, v244, v180
  v_add_f32 v245, v245, v181
  v_add_f32 v246, v246, v182
  v_add_f32 v247, v247, v183
  v_add_f32 v248, v248, v184
  v_add_f32 v249, v249, v185
  v_add_f32 v250, v250, v186
  v_add_f32 v251, v251, v187
  v_add_f32 v252, v252, v188
  v_add_f32 v253, v253, v189
  v_add_f32 v254, v254, v190
  v_add_f32 v255, v255, v191
  ds_swizzle_b32 v176, v240 offset:0x401f
  ds_swizzle_b32 v177, v241 offset:0x401f
  ds_swizzle_b32 v178, v242 offset:0x401f
  ds_swizzle_b32 v179, v243 offset:0x401f
  ds_swizzle_b32 v180, v244 offset:0x401f
  ds_swizzle_b32 v181, v245 offset:0x401f
  ds_swizzle_b32 v182, v246 offset:0x401f
  ds_swizzle_b32 v183, v247 offset:0x401f
  ds_swizzle_b32 v184, v248 offset:0x401f
  ds_swizzle_b32 v185, v249 offset:0x401f
  ds_swizzle_b32 v186, v250 offset:0x401f
  ds_swizzle_b32 v187, v251 offset:0x401f
  ds_swizzle_b32 v188, v252 offset:0x401f
  ds_swizzle_b32 v189, v253 offset:0x401f
  ds_swizzle_b32 v190, v254 offset:0x401f
  ds_swizzle_b32 v191, v255 offset:0x401f
  s_waitcnt lgkmcnt(0)
  v_add_f32 v240, v240, v176
  v_add_f32 v241, v241, v177
  v_add_f32 v242, v242, v178
  v_add_f32 v243, v243, v179
  v_add_f32 v244, v244, v180
  v_add_f32 v245, v245, v181
  v_add_f32 v246, v246, v182
  v_add_f32 v247, v247, v183
  v_add_f32 v248, v248, v184
  v_add_f32 v249, v249, v185
  v_add_f32 v250, v250, v186
  v_add_f32 v251, v251, v187
  v_add_f32 v252, v252, v188
  v_add_f32 v253, v253, v189
  v_add_f32 v254, v254, v190
  v_add_f32 v255, v255, v191
  v_mov_b32 v12, v240
  v_mov_b32 v13, v240
  s_nop 1
  v_permlane32_swap_b32 v12, v13
  s_nop 1
  v_add_f32 v240, v12, v13
  v_mov_b32 v12, v241
  v_mov_b32 v13, v241
  s_nop 1
  v_permlane32_swap_b32 v12, v13
  s_nop 1
  v_add_f32 v241, v12, v13
  v_mov_b32 v12, v242
  v_mov_b32 v13, v242
  s_nop 1
  v_permlane32_swap_b32 v12, v13
  s_nop 1
  v_add_f32 v242, v12, v13
  v_mov_b32 v12, v243
  v_mov_b32 v13, v243
  s_nop 1
  v_permlane32_swap_b32 v12, v13
  s_nop 1
  v_add_f32 v243, v12, v13
  v_mov_b32 v12, v244
  v_mov_b32 v13, v244
  s_nop 1
  v_permlane32_swap_b32 v12, v13
  s_nop 1
  v_add_f32 v244, v12, v13
  v_mov_b32 v12, v245
  v_mov_b32 v13, v245
  s_nop 1
  v_permlane32_swap_b32 v12, v13
  s_nop 1
  v_add_f32 v245, v12, v13
  v_mov_b32 v12, v246
  v_mov_b32 v13, v246
  s_nop 1
  v_permlane32_swap_b32 v12, v13
  s_nop 1
  v_add_f32 v246, v12, v13
  v_mov_b32 v12, v247
  v_mov_b32 v13, v247
  s_nop 1
  v_permlane32_swap_b32 v12, v13
  s_nop 1
  v_add_f32 v247, v12, v13
  v_mov_b32 v12, v248
  v_mov_b32 v13, v248
  s_nop 1
  v_permlane32_swap_b32 v12, v13
  s_nop 1
  v_add_f32 v248, v12, v13
  v_mov_b32 v12, v249
  v_mov_b32 v13, v249
  s_nop 1
  v_permlane32_swap_b32 v12, v13
  s_nop 1
  v_add_f32 v249, v12, v13
  v_mov_b32 v12, v250
  v_mov_b32 v13, v250
  s_nop 1
  v_permlane32_swap_b32 v12, v13
  s_nop 1
  v_add_f32 v250, v12, v13
  v_mov_b32 v12, v251
  v_mov_b32 v13, v251
  s_nop 1
  v_permlane32_swap_b32 v12, v13
  s_nop 1
  v_add_f32 v251, v12, v13
  v_mov_b32 v12, v252
  v_mov_b32 v13, v252
  s_nop 1
  v_permlane32_swap_b32 v12, v13
  s_nop 1
  v_add_f32 v252, v12, v13
  v_mov_b32 v12, v253
  v_mov_b32 v13, v253
  s_nop 1
  v_permlane32_swap_b32 v12, v13
  s_nop 1
  v_add_f32 v253, v12, v13
  v_mov_b32 v12, v254
  v_mov_b32 v13, v254
  s_nop 1
  v_permlane32_swap_b32 v12, v13
  s_nop 1
  v_add_f32 v254, v12, v13
  v_mov_b32 v12, v255
  v_mov_b32 v13, v255
  s_nop 1
  v_permlane32_swap_b32 v12, v13
  s_nop 1
  v_add_f32 v255, v12, v13
  s_lshl_b32 s67, s48, 10
  s_add_u32 s67, s67, 153216
  v_lshlrev_b32 v12, 5, v6
  v_add_u32 v12, s67, v12
  s_mov_b64 exec, 0xff
  ds_write_b128 v12, v[240:243] offset:0
  ds_write_b128 v12, v[244:247] offset:16
  ds_write_b128 v12, v[248:251] offset:256
  ds_write_b128 v12, v[252:255] offset:272
  s_mov_b64 exec, -1
  s_waitcnt lgkmcnt(0)
  s_barrier
  v_lshlrev_b32 v12, 5, v5
  v_add_u32 v12, 153216, v12
  ds_read_b128 v[128:131], v12 offset:0
  ds_read_b128 v[132:135], v12 offset:16
  ds_read_b128 v[136:139], v12 offset:256
  ds_read_b128 v[140:143], v12 offset:272
  ds_read_b128 v[144:147], v12 offset:1024
  ds_read_b128 v[148:151], v12 offset:1040
  ds_read_b128 v[152:155], v12 offset:1280
  ds_read_b128 v[156:159], v12 offset:1296
  ds_read_b128 v[160:163], v12 offset:2048
  ds_read_b128 v[164:167], v12 offset:2064
  ds_read_b128 v[168:171], v12 offset:2304
  ds_read_b128 v[172:175], v12 offset:2320
  ds_read_b128 v[176:179], v12 offset:3072
  ds_read_b128 v[180:183], v12 offset:3088
  ds_read_b128 v[184:187], v12 offset:3328
  ds_read_b128 v[188:191], v12 offset:3344
  s_waitcnt lgkmcnt(0)
  v_add_f32 v16, v128, v144
  v_add_f32 v160, v160, v176
  v_add_f32 v16, v16, v160
  v_add_f32 v17, v129, v145
  v_add_f32 v161, v161, v177
  v_add_f32 v17, v17, v161
  v_add_f32 v18, v130, v146
  v_add_f32 v162, v162, v178
  v_add_f32 v18, v18, v162
  v_add_f32 v19, v131, v147
  v_add_f32 v163, v163, v179
  v_add_f32 v19, v19, v163
  v_add_f32 v20, v132, v148
  v_add_f32 v164, v164, v180
  v_add_f32 v20, v20, v164
  v_add_f32 v21, v133, v149
  v_add_f32 v165, v165, v181
  v_add_f32 v21, v21, v165
  v_add_f32 v22, v134, v150
  v_add_f32 v166, v166, v182
  v_add_f32 v22, v22, v166
  v_add_f32 v23, v135, v151
  v_add_f32 v167, v167, v183
  v_add_f32 v23, v23, v167
  v_add_f32 v24, v136, v152
  v_add_f32 v168, v168, v184
  v_add_f32 v24, v24, v168
  v_add_f32 v25, v137, v153
  v_add_f32 v169, v169, v185
  v_add_f32 v25, v25, v169
  v_add_f32 v26, v138, v154
  v_add_f32 v170, v170, v186
  v_add_f32 v26, v26, v170
  v_add_f32 v27, v139, v155
  v_add_f32 v171, v171, v187
  v_add_f32 v27, v27, v171
  v_add_f32 v28, v140, v156
  v_add_f32 v172, v172, v188
  v_add_f32 v28, v28, v172
  v_add_f32 v29, v141, v157
  v_add_f32 v173, v173, v189
  v_add_f32 v29, v29, v173
  v_add_f32 v30, v142, v158
  v_add_f32 v174, v174, v190
  v_add_f32 v30, v30, v174
  v_add_f32 v31, v143, v159
  v_add_f32 v175, v175, v191
  v_add_f32 v31, v31, v175
  ds_read_b128 v[128:131], v12 offset:4096
  ds_read_b128 v[132:135], v12 offset:4112
  ds_read_b128 v[136:139], v12 offset:4352
  ds_read_b128 v[140:143], v12 offset:4368
  ds_read_b128 v[144:147], v12 offset:5120
  ds_read_b128 v[148:151], v12 offset:5136
  ds_read_b128 v[152:155], v12 offset:5376
  ds_read_b128 v[156:159], v12 offset:5392
  ds_read_b128 v[160:163], v12 offset:6144
  ds_read_b128 v[164:167], v12 offset:6160
  ds_read_b128 v[168:171], v12 offset:6400
  ds_read_b128 v[172:175], v12 offset:6416
  ds_read_b128 v[176:179], v12 offset:7168
  ds_read_b128 v[180:183], v12 offset:7184
  ds_read_b128 v[184:187], v12 offset:7424
  ds_read_b128 v[188:191], v12 offset:7440
  s_waitcnt lgkmcnt(0)
  v_add_f32 v128, v128, v144
  v_add_f32 v160, v160, v176
  v_add_f32 v128, v128, v160
  v_add_f32 v16, v16, v128
  v_add_f32 v129, v129, v145
  v_add_f32 v161, v161, v177
  v_add_f32 v129, v129, v161
  v_add_f32 v17, v17, v129
  v_add_f32 v130, v130, v146
  v_add_f32 v162, v162, v178
  v_add_f32 v130, v130, v162
  v_add_f32 v18, v18, v130
  v_add_f32 v131, v131, v147
  v_add_f32 v163, v163, v179
  v_add_f32 v131, v131, v163
  v_add_f32 v19, v19, v131
  v_add_f32 v132, v132, v148
  v_add_f32 v164, v164, v180
  v_add_f32 v132, v132, v164
  v_add_f32 v20, v20, v132
  v_add_f32 v133, v133, v149
  v_add_f32 v165, v165, v181
  v_add_f32 v133, v133, v165
  v_add_f32 v21, v21, v133
  v_add_f32 v134, v134, v150
  v_add_f32 v166, v166, v182
  v_add_f32 v134, v134, v166
  v_add_f32 v22, v22, v134
  v_add_f32 v135, v135, v151
  v_add_f32 v167, v167, v183
  v_add_f32 v135, v135, v167
  v_add_f32 v23, v23, v135
  v_add_f32 v136, v136, v152
  v_add_f32 v168, v168, v184
  v_add_f32 v136, v136, v168
  v_add_f32 v24, v24, v136
  v_add_f32 v137, v137, v153
  v_add_f32 v169, v169, v185
  v_add_f32 v137, v137, v169
  v_add_f32 v25, v25, v137
  v_add_f32 v138, v138, v154
  v_add_f32 v170, v170, v186
  v_add_f32 v138, v138, v170
  v_add_f32 v26, v26, v138
  v_add_f32 v139, v139, v155
  v_add_f32 v171, v171, v187
  v_add_f32 v139, v139, v171
  v_add_f32 v27, v27, v139
  v_add_f32 v140, v140, v156
  v_add_f32 v172, v172, v188
  v_add_f32 v140, v140, v172
  v_add_f32 v28, v28, v140
  v_add_f32 v141, v141, v157
  v_add_f32 v173, v173, v189
  v_add_f32 v141, v141, v173
  v_add_f32 v29, v29, v141
  v_add_f32 v142, v142, v158
  v_add_f32 v174, v174, v190
  v_add_f32 v142, v142, v174
  v_add_f32 v30, v30, v142
  v_add_f32 v143, v143, v159
  v_add_f32 v175, v175, v191
  v_add_f32 v143, v143, v175
  v_add_f32 v31, v31, v143
  v_cvt_pk_bf16_f32 v12, v16, v17
  v_lshlrev_b32 v16, 16, v12
  v_and_b32 v17, 0xffff0000, v12
  v_cvt_pk_bf16_f32 v12, v18, v19
  v_lshlrev_b32 v18, 16, v12
  v_and_b32 v19, 0xffff0000, v12
  v_cvt_pk_bf16_f32 v12, v20, v21
  v_lshlrev_b32 v20, 16, v12
  v_and_b32 v21, 0xffff0000, v12
  v_cvt_pk_bf16_f32 v12, v22, v23
  v_lshlrev_b32 v22, 16, v12
  v_and_b32 v23, 0xffff0000, v12
  v_cvt_pk_bf16_f32 v12, v24, v25
  v_lshlrev_b32 v24, 16, v12
  v_and_b32 v25, 0xffff0000, v12
  v_cvt_pk_bf16_f32 v12, v26, v27
  v_lshlrev_b32 v26, 16, v12
  v_and_b32 v27, 0xffff0000, v12
  v_cvt_pk_bf16_f32 v12, v28, v29
  v_lshlrev_b32 v28, 16, v12
  v_and_b32 v29, 0xffff0000, v12
  v_cvt_pk_bf16_f32 v12, v30, v31
  v_lshlrev_b32 v30, 16, v12
  v_and_b32 v31, 0xffff0000, v12
  v_mov_b32 v240, 0
  v_mov_b32 v241, 0
  v_mov_b32 v242, 0
  v_mov_b32 v243, 0
  v_mov_b32 v244, 0
  v_mov_b32 v245, 0
  v_mov_b32 v246, 0
  v_mov_b32 v247, 0
  v_mov_b32 v248, 0
  v_mov_b32 v249, 0
  v_mov_b32 v250, 0
  v_mov_b32 v251, 0
  v_mov_b32 v252, 0
  v_mov_b32 v253, 0
  v_mov_b32 v254, 0
  v_mov_b32 v255, 0
  v_lshlrev_b32 v12, 16, v96
  v_and_b32 v13, 0xffff0000, v96
  v_fmac_f32 v240, v16, v12
  v_fmac_f32 v241, v16, v13
  v_fmac_f32 v248, v24, v12
  v_fmac_f32 v249, v24, v13
  v_lshlrev_b32 v12, 16, v97
  v_and_b32 v13, 0xffff0000, v97
  v_fmac_f32 v242, v16, v12
  v_fmac_f32 v243, v16, v13
  v_fmac_f32 v250, v24, v12
  v_fmac_f32 v251, v24, v13
  v_lshlrev_b32 v12, 16, v98
  v_and_b32 v13, 0xffff0000, v98
  v_fmac_f32 v244, v16, v12
  v_fmac_f32 v245, v16, v13
  v_fmac_f32 v252, v24, v12
  v_fmac_f32 v253, v24, v13
  v_lshlrev_b32 v12, 16, v99
  v_and_b32 v13, 0xffff0000, v99
  v_fmac_f32 v246, v16, v12
  v_fmac_f32 v247, v16, v13
  v_fmac_f32 v254, v24, v12
  v_fmac_f32 v255, v24, v13
  v_lshlrev_b32 v12, 16, v100
  v_and_b32 v13, 0xffff0000, v100
  v_fmac_f32 v240, v17, v12
  v_fmac_f32 v241, v17, v13
  v_fmac_f32 v248, v25, v12
  v_fmac_f32 v249, v25, v13
  v_lshlrev_b32 v12, 16, v101
  v_and_b32 v13, 0xffff0000, v101
  v_fmac_f32 v242, v17, v12
  v_fmac_f32 v243, v17, v13
  v_fmac_f32 v250, v25, v12
  v_fmac_f32 v251, v25, v13
  v_lshlrev_b32 v12, 16, v102
  v_and_b32 v13, 0xffff0000, v102
  v_fmac_f32 v244, v17, v12
  v_fmac_f32 v245, v17, v13
  v_fmac_f32 v252, v25, v12
  v_fmac_f32 v253, v25, v13
  v_lshlrev_b32 v12, 16, v103
  v_and_b32 v13, 0xffff0000, v103
  v_fmac_f32 v246, v17, v12
  v_fmac_f32 v247, v17, v13
  v_fmac_f32 v254, v25, v12
  v_fmac_f32 v255, v25, v13
  v_lshlrev_b32 v12, 16, v104
  v_and_b32 v13, 0xffff0000, v104
  v_fmac_f32 v240, v18, v12
  v_fmac_f32 v241, v18, v13
  v_fmac_f32 v248, v26, v12
  v_fmac_f32 v249, v26, v13
  v_lshlrev_b32 v12, 16, v105
  v_and_b32 v13, 0xffff0000, v105
  v_fmac_f32 v242, v18, v12
  v_fmac_f32 v243, v18, v13
  v_fmac_f32 v250, v26, v12
  v_fmac_f32 v251, v26, v13
  v_lshlrev_b32 v12, 16, v106
  v_and_b32 v13, 0xffff0000, v106
  v_fmac_f32 v244, v18, v12
  v_fmac_f32 v245, v18, v13
  v_fmac_f32 v252, v26, v12
  v_fmac_f32 v253, v26, v13
  v_lshlrev_b32 v12, 16, v107
  v_and_b32 v13, 0xffff0000, v107
  v_fmac_f32 v246, v18, v12
  v_fmac_f32 v247, v18, v13
  v_fmac_f32 v254, v26, v12
  v_fmac_f32 v255, v26, v13
  v_lshlrev_b32 v12, 16, v108
  v_and_b32 v13, 0xffff0000, v108
  v_fmac_f32 v240, v19, v12
  v_fmac_f32 v241, v19, v13
  v_fmac_f32 v248, v27, v12
  v_fmac_f32 v249, v27, v13
  v_lshlrev_b32 v12, 16, v109
  v_and_b32 v13, 0xffff0000, v109
  v_fmac_f32 v242, v19, v12
  v_fmac_f32 v243, v19, v13
  v_fmac_f32 v250, v27, v12
  v_fmac_f32 v251, v27, v13
  v_lshlrev_b32 v12, 16, v110
  v_and_b32 v13, 0xffff0000, v110
  v_fmac_f32 v244, v19, v12
  v_fmac_f32 v245, v19, v13
  v_fmac_f32 v252, v27, v12
  v_fmac_f32 v253, v27, v13
  v_lshlrev_b32 v12, 16, v111
  v_and_b32 v13, 0xffff0000, v111
  v_fmac_f32 v246, v19, v12
  v_fmac_f32 v247, v19, v13
  v_fmac_f32 v254, v27, v12
  v_fmac_f32 v255, v27, v13
  v_lshlrev_b32 v12, 16, v112
  v_and_b32 v13, 0xffff0000, v112
  v_fmac_f32 v240, v20, v12
  v_fmac_f32 v241, v20, v13
  v_fmac_f32 v248, v28, v12
  v_fmac_f32 v249, v28, v13
  v_lshlrev_b32 v12, 16, v113
  v_and_b32 v13, 0xffff0000, v113
  v_fmac_f32 v242, v20, v12
  v_fmac_f32 v243, v20, v13
  v_fmac_f32 v250, v28, v12
  v_fmac_f32 v251, v28, v13
  v_lshlrev_b32 v12, 16, v114
  v_and_b32 v13, 0xffff0000, v114
  v_fmac_f32 v244, v20, v12
  v_fmac_f32 v245, v20, v13
  v_fmac_f32 v252, v28, v12
  v_fmac_f32 v253, v28, v13
  v_lshlrev_b32 v12, 16, v115
  v_and_b32 v13, 0xffff0000, v115
  v_fmac_f32 v246, v20, v12
  v_fmac_f32 v247, v20, v13
  v_fmac_f32 v254, v28, v12
  v_fmac_f32 v255, v28, v13
  v_lshlrev_b32 v12, 16, v116
  v_and_b32 v13, 0xffff0000, v116
  v_fmac_f32 v240, v21, v12
  v_fmac_f32 v241, v21, v13
  v_fmac_f32 v248, v29, v12
  v_fmac_f32 v249, v29, v13
  v_lshlrev_b32 v12, 16, v117
  v_and_b32 v13, 0xffff0000, v117
  v_fmac_f32 v242, v21, v12
  v_fmac_f32 v243, v21, v13
  v_fmac_f32 v250, v29, v12
  v_fmac_f32 v251, v29, v13
  v_lshlrev_b32 v12, 16, v118
  v_and_b32 v13, 0xffff0000, v118
  v_fmac_f32 v244, v21, v12
  v_fmac_f32 v245, v21, v13
  v_fmac_f32 v252, v29, v12
  v_fmac_f32 v253, v29, v13
  v_lshlrev_b32 v12, 16, v119
  v_and_b32 v13, 0xffff0000, v119
  v_fmac_f32 v246, v21, v12
  v_fmac_f32 v247, v21, v13
  v_fmac_f32 v254, v29, v12
  v_fmac_f32 v255, v29, v13
  v_lshlrev_b32 v12, 16, v120
  v_and_b32 v13, 0xffff0000, v120
  v_fmac_f32 v240, v22, v12
  v_fmac_f32 v241, v22, v13
  v_fmac_f32 v248, v30, v12
  v_fmac_f32 v249, v30, v13
  v_lshlrev_b32 v12, 16, v121
  v_and_b32 v13, 0xffff0000, v121
  v_fmac_f32 v242, v22, v12
  v_fmac_f32 v243, v22, v13
  v_fmac_f32 v250, v30, v12
  v_fmac_f32 v251, v30, v13
  v_lshlrev_b32 v12, 16, v122
  v_and_b32 v13, 0xffff0000, v122
  v_fmac_f32 v244, v22, v12
  v_fmac_f32 v245, v22, v13
  v_fmac_f32 v252, v30, v12
  v_fmac_f32 v253, v30, v13
  v_lshlrev_b32 v12, 16, v123
  v_and_b32 v13, 0xffff0000, v123
  v_fmac_f32 v246, v22, v12
  v_fmac_f32 v247, v22, v13
  v_fmac_f32 v254, v30, v12
  v_fmac_f32 v255, v30, v13
  v_lshlrev_b32 v12, 16, v124
  v_and_b32 v13, 0xffff0000, v124
  v_fmac_f32 v240, v23, v12
  v_fmac_f32 v241, v23, v13
  v_fmac_f32 v248, v31, v12
  v_fmac_f32 v249, v31, v13
  v_lshlrev_b32 v12, 16, v125
  v_and_b32 v13, 0xffff0000, v125
  v_fmac_f32 v242, v23, v12
  v_fmac_f32 v243, v23, v13
  v_fmac_f32 v250, v31, v12
  v_fmac_f32 v251, v31, v13
  v_lshlrev_b32 v12, 16, v126
  v_and_b32 v13, 0xffff0000, v126
  v_fmac_f32 v244, v23, v12
  v_fmac_f32 v245, v23, v13
  v_fmac_f32 v252, v31, v12
  v_fmac_f32 v253, v31, v13
  v_lshlrev_b32 v12, 16, v127
  v_and_b32 v13, 0xffff0000, v127
  v_fmac_f32 v246, v23, v12
  v_fmac_f32 v247, v23, v13
  v_fmac_f32 v254, v31, v12
  v_fmac_f32 v255, v31, v13
  ds_swizzle_b32 v176, v240 offset:0x201f
  ds_swizzle_b32 v177, v241 offset:0x201f
  ds_swizzle_b32 v178, v242 offset:0x201f
  ds_swizzle_b32 v179, v243 offset:0x201f
  ds_swizzle_b32 v180, v244 offset:0x201f
  ds_swizzle_b32 v181, v245 offset:0x201f
  ds_swizzle_b32 v182, v246 offset:0x201f
  ds_swizzle_b32 v183, v247 offset:0x201f
  ds_swizzle_b32 v184, v248 offset:0x201f
  ds_swizzle_b32 v185, v249 offset:0x201f
  ds_swizzle_b32 v186, v250 offset:0x201f
  ds_swizzle_b32 v187, v251 offset:0x201f
  ds_swizzle_b32 v188, v252 offset:0x201f
  ds_swizzle_b32 v189, v253 offset:0x201f
  ds_swizzle_b32 v190, v254 offset:0x201f
  ds_swizzle_b32 v191, v255 offset:0x201f
  s_waitcnt lgkmcnt(0)
  v_add_f32 v240, v240, v176
  v_add_f32 v241, v241, v177
  v_add_f32 v242, v242, v178
  v_add_f32 v243, v243, v179
  v_add_f32 v244, v244, v180
  v_add_f32 v245, v245, v181
  v_add_f32 v246, v246, v182
  v_add_f32 v247, v247, v183
  v_add_f32 v248, v248, v184
  v_add_f32 v249, v249, v185
  v_add_f32 v250, v250, v186
  v_add_f32 v251, v251, v187
  v_add_f32 v252, v252, v188
  v_add_f32 v253, v253, v189
  v_add_f32 v254, v254, v190
  v_add_f32 v255, v255, v191
  ds_swizzle_b32 v176, v240 offset:0x401f
  ds_swizzle_b32 v177, v241 offset:0x401f
  ds_swizzle_b32 v178, v242 offset:0x401f
  ds_swizzle_b32 v179, v243 offset:0x401f
  ds_swizzle_b32 v180, v244 offset:0x401f
  ds_swizzle_b32 v181, v245 offset:0x401f
  ds_swizzle_b32 v182, v246 offset:0x401f
  ds_swizzle_b32 v183, v247 offset:0x401f
  ds_swizzle_b32 v184, v248 offset:0x401f
  ds_swizzle_b32 v185, v249 offset:0x401f
  ds_swizzle_b32 v186, v250 offset:0x401f
  ds_swizzle_b32 v187, v251 offset:0x401f
  ds_swizzle_b32 v188, v252 offset:0x401f
  ds_swizzle_b32 v189, v253 offset:0x401f
  ds_swizzle_b32 v190, v254 offset:0x401f
  ds_swizzle_b32 v191, v255 offset:0x401f
  s_waitcnt lgkmcnt(0)
  v_add_f32 v240, v240, v176
  v_add_f32 v241, v241, v177
  v_add_f32 v242, v242, v178
  v_add_f32 v243, v243, v179
  v_add_f32 v244, v244, v180
  v_add_f32 v245, v245, v181
  v_add_f32 v246, v246, v182
  v_add_f32 v247, v247, v183
  v_add_f32 v248, v248, v184
  v_add_f32 v249, v249, v185
  v_add_f32 v250, v250, v186
  v_add_f32 v251, v251, v187
  v_add_f32 v252, v252, v188
  v_add_f32 v253, v253, v189
  v_add_f32 v254, v254, v190
  v_add_f32 v255, v255, v191
  v_mov_b32 v12, v240
  v_mov_b32 v13, v240
  s_nop 1
  v_permlane32_swap_b32 v12, v13
  s_nop 1
  v_add_f32 v240, v12, v13
  v_mov_b32 v12, v241
  v_mov_b32 v13, v241
  s_nop 1
  v_permlane32_swap_b32 v12, v13
  s_nop 1
  v_add_f32 v241, v12, v13
  v_mov_b32 v12, v242
  v_mov_b32 v13, v242
  s_nop 1
  v_permlane32_swap_b32 v12, v13
  s_nop 1
  v_add_f32 v242, v12, v13
  v_mov_b32 v12, v243
  v_mov_b32 v13, v243
  s_nop 1
  v_permlane32_swap_b32 v12, v13
  s_nop 1
  v_add_f32 v243, v12, v13
  v_mov_b32 v12, v244
  v_mov_b32 v13, v244
  s_nop 1
  v_permlane32_swap_b32 v12, v13
  s_nop 1
  v_add_f32 v244, v12, v13
  v_mov_b32 v12, v245
  v_mov_b32 v13, v245
  s_nop 1
  v_permlane32_swap_b32 v12, v13
  s_nop 1
  v_add_f32 v245, v12, v13
  v_mov_b32 v12, v246
  v_mov_b32 v13, v246
  s_nop 1
  v_permlane32_swap_b32 v12, v13
  s_nop 1
  v_add_f32 v246, v12, v13
  v_mov_b32 v12, v247
  v_mov_b32 v13, v247
  s_nop 1
  v_permlane32_swap_b32 v12, v13
  s_nop 1
  v_add_f32 v247, v12, v13
  v_mov_b32 v12, v248
  v_mov_b32 v13, v248
  s_nop 1
  v_permlane32_swap_b32 v12, v13
  s_nop 1
  v_add_f32 v248, v12, v13
  v_mov_b32 v12, v249
  v_mov_b32 v13, v249
  s_nop 1
  v_permlane32_swap_b32 v12, v13
  s_nop 1
  v_add_f32 v249, v12, v13
  v_mov_b32 v12, v250
  v_mov_b32 v13, v250
  s_nop 1
  v_permlane32_swap_b32 v12, v13
  s_nop 1
  v_add_f32 v250, v12, v13
  v_mov_b32 v12, v251
  v_mov_b32 v13, v251
  s_nop 1
  v_permlane32_swap_b32 v12, v13
  s_nop 1
  v_add_f32 v251, v12, v13
  v_mov_b32 v12, v252
  v_mov_b32 v13, v252
  s_nop 1
  v_permlane32_swap_b32 v12, v13
  s_nop 1
  v_add_f32 v252, v12, v13
  v_mov_b32 v12, v253
  v_mov_b32 v13, v253
  s_nop 1
  v_permlane32_swap_b32 v12, v13
  s_nop 1
  v_add_f32 v253, v12, v13
  v_mov_b32 v12, v254
  v_mov_b32 v13, v254
  s_nop 1
  v_permlane32_swap_b32 v12, v13
  s_nop 1
  v_add_f32 v254, v12, v13
  v_mov_b32 v12, v255
  v_mov_b32 v13, v255
  s_nop 1
  v_permlane32_swap_b32 v12, v13
  s_nop 1
  v_add_f32 v255, v12, v13
  s_lshl_b32 s66, s2, 12
  s_lshl_b32 s67, s48, 8
  s_add_u32 s66, s66, s67
  s_add_u32 s92, s42, s66
  s_addc_u32 s93, s43, 0
  s_add_u32 s92, s92, 196608
  s_addc_u32 s93, s93, 0
  v_lshlrev_b32 v12, 5, v6
  s_mov_b64 exec, 0xff
  global_store_dwordx4 v12, v[240:243], s[92:93] offset:0 sc1
  global_store_dwordx4 v12, v[244:247], s[92:93] offset:16 sc1
  global_store_dwordx4 v12, v[248:251], s[92:93] offset:2048 sc1
  global_store_dwordx4 v12, v[252:255], s[92:93] offset:2064 sc1
  s_mov_b64 exec, -1
  s_lshl_b32 s64, s2, 2
  s_add_u32 s64, s64, s48
  s_lshr_b32 s65, s64, 7
  s_and_b32 s64, s64, 127
  s_mov_b32 s46, s45
  s_mov_b32 s47, 3
  s_branch L_bprog
L_bfinal:
  s_and_b32 s67, s48, 3
  s_lshl_b32 s64, s83, 2
  s_add_u32 s64, s64, s67
  s_lshr_b32 s65, s64, 7
  s_and_b32 s64, s64, 127
  s_cmp_ge_u32 s48, 4
  s_cbranch_scc1 L_afinal
  v_lshlrev_b32 v12, 11, v1
  v_add_u32 v13, 0x20000, v12
  v_lshrrev_b32 v14, 2, v1
  v_lshlrev_b32 v14, 5, v14
  v_add_u32 v15, 512, v14
  v_and_b32 v22, 3, v1
  s_lshl_b32 s68, s65, 18
  s_lshl_b32 s67, s64, 4
  s_add_u32 s67, s68, s67
  s_add_u32 s88, s42, s67
  s_addc_u32 s89, s43, 0
  s_add_u32 s88, s88, 1048576
  s_addc_u32 s89, s89, 0
  s_lshl_b32 s66, s65, 10
  s_add_u32 s94, s42, s66
  s_addc_u32 s95, s43, 0
  s_add_u32 s94, s94, 917504
  s_addc_u32 s95, s95, 0
  s_cmp_eq_u32 s48, 0
  s_cbranch_scc0 L_pbd_15
  s_and_b32 s78, s2, 15
  s_lshl_b32 s78, s78, 7
  s_add_u32 s90, s42, s78
  s_addc_u32 s91, s43, 0
  s_add_u32 s90, s90, 987136
  s_addc_u32 s91, s91, 0
  s_mov_b32 s79, 0
L_poll_16:
  global_load_dword v16, v4, s[90:91] offset:0 sc1
  s_waitcnt vmcnt(0)
  v_readfirstlane_b32 s66, v16
  s_cmp_ge_u32 s66, 64
  s_cbranch_scc1 L_polld_17
  s_sleep 1
  s_add_u32 s79, s79, 1
  s_cmp_lt_u32 s79, 0x20000
  s_cbranch_scc1 L_poll_16
L_polld_17:
  s_lshl_b32 s77, s65, 11
  s_and_b32 s78, s2, 15
  s_lshl_b32 s78, s78, 7
  s_add_u32 s78, s78, s77
  s_add_u32 s92, s42, s78
  s_addc_u32 s93, s43, 0
  s_add_u32 s92, s92, 983040
  s_addc_u32 s93, s93, 0
  s_mov_b32 s79, 0
L_poll_18:
  global_load_dword v16, v4, s[92:93] offset:0 sc1
  s_waitcnt vmcnt(0)
  v_readfirstlane_b32 s66, v16
  s_cmp_ge_u32 s66, 128
  s_cbranch_scc1 L_polld_19
  s_sleep 1
  s_add_u32 s79, s79, 1
  s_cmp_lt_u32 s79, 0x20000
  s_cbranch_scc1 L_poll_18
L_polld_19:
L_pbd_15:
  s_barrier
  global_load_dwordx4 v[16:19], v12, s[88:89] sc1
  global_load_dwordx4 v[24:27], v14, s[94:95] offset:0 sc1
  global_load_dwordx4 v[28:31], v14, s[94:95] offset:16 sc1
  global_load_dwordx4 v[44:47], v13, s[88:89] sc1
  global_load_dwordx4 v[52:55], v15, s[94:95] offset:0 sc1
  global_load_dwordx4 v[56:59], v15, s[94:95] offset:16 sc1
  s_waitcnt vmcnt(3)
  v_max3_f32 v32, v24, v26, v28
  v_max_f32 v32, v32, v30
  v_sub_f32 v24, v24, v32
  v_mul_f32 v24, s80, v24
  v_exp_f32 v24, v24
  v_sub_f32 v26, v26, v32
  v_mul_f32 v26, s80, v26
  v_exp_f32 v26, v26
  v_sub_f32 v28, v28, v32
  v_mul_f32 v28, s80, v28
  v_exp_f32 v28, v28
  v_sub_f32 v30, v30, v32
  v_mul_f32 v30, s80, v30
  v_exp_f32 v30, v30
  s_nop 0
  v_mul_f32 v33, v24, v25
  v_fmac_f32 v33, v26, v27
  v_fmac_f32 v33, v28, v29
  v_fmac_f32 v33, v30, v31
  v_rcp_f32 v33, v33
  v_cmp_eq_u32 vcc, 1, v22
  s_nop 1
  v_cndmask_b32 v24, v24, v26, vcc
  v_cmp_eq_u32 vcc, 2, v22
  s_nop 1
  v_cndmask_b32 v24, v24, v28, vcc
  v_cmp_eq_u32 vcc, 3, v22
  s_nop 1
  v_cndmask_b32 v24, v24, v30, vcc
  v_mul_f32 v24, v24, v33
  v_mul_f32 v16, v16, v24
  v_mul_f32 v17, v17, v24
  v_mul_f32 v18, v18, v24
  v_mul_f32 v19, v19, v24
  s_waitcnt vmcnt(0)
  v_max3_f32 v60, v52, v54, v56
  v_max_f32 v60, v60, v58
  v_sub_f32 v52, v52, v60
  v_mul_f32 v52, s80, v52
  v_exp_f32 v52, v52
  v_sub_f32 v54, v54, v60
  v_mul_f32 v54, s80, v54
  v_exp_f32 v54, v54
  v_sub_f32 v56, v56, v60
  v_mul_f32 v56, s80, v56
  v_exp_f32 v56, v56
  v_sub_f32 v58, v58, v60
  v_mul_f32 v58, s80, v58
  v_exp_f32 v58, v58
  s_nop 0
  v_mul_f32 v61, v52, v53
  v_fmac_f32 v61, v54, v55
  v_fmac_f32 v61, v56, v57
  v_fmac_f32 v61, v58, v59
  v_rcp_f32 v61, v61
  v_cmp_eq_u32 vcc, 1, v22
  s_nop 1
  v_cndmask_b32 v52, v52, v54, vcc
  v_cmp_eq_u32 vcc, 2, v22
  s_nop 1
  v_cndmask_b32 v52, v52, v56, vcc
  v_cmp_eq_u32 vcc, 3, v22
  s_nop 1
  v_cndmask_b32 v52, v52, v58, vcc
  v_mul_f32 v52, v52, v61
  v_fmac_f32 v16, v44, v52
  v_fmac_f32 v17, v45, v52
  v_fmac_f32 v18, v46, v52
  v_fmac_f32 v19, v47, v52
  s_nop 1
  v_add_f32_dpp v16, v16, v16 row_ror:8 row_mask:0xf bank_mask:0xf
  v_add_f32_dpp v17, v17, v17 row_ror:8 row_mask:0xf bank_mask:0xf
  v_add_f32_dpp v18, v18, v18 row_ror:8 row_mask:0xf bank_mask:0xf
  v_add_f32_dpp v19, v19, v19 row_ror:8 row_mask:0xf bank_mask:0xf
  v_add_f32_dpp v16, v16, v16 row_ror:4 row_mask:0xf bank_mask:0xf
  v_add_f32_dpp v17, v17, v17 row_ror:4 row_mask:0xf bank_mask:0xf
  v_add_f32_dpp v18, v18, v18 row_ror:4 row_mask:0xf bank_mask:0xf
  v_add_f32_dpp v19, v19, v19 row_ror:4 row_mask:0xf bank_mask:0xf
  v_add_f32_dpp v16, v16, v16 row_ror:2 row_mask:0xf bank_mask:0xf
  v_add_f32_dpp v17, v17, v17 row_ror:2 row_mask:0xf bank_mask:0xf
  v_add_f32_dpp v18, v18, v18 row_ror:2 row_mask:0xf bank_mask:0xf
  v_add_f32_dpp v19, v19, v19 row_ror:2 row_mask:0xf bank_mask:0xf
  v_add_f32_dpp v16, v16, v16 row_ror:1 row_mask:0xf bank_mask:0xf
  v_add_f32_dpp v17, v17, v17 row_ror:1 row_mask:0xf bank_mask:0xf
  v_add_f32_dpp v18, v18, v18 row_ror:1 row_mask:0xf bank_mask:0xf
  v_add_f32_dpp v19, v19, v19 row_ror:1 row_mask:0xf bank_mask:0xf
  ds_swizzle_b32 v40, v16 offset:0x401f
  ds_swizzle_b32 v41, v17 offset:0x401f
  ds_swizzle_b32 v42, v18 offset:0x401f
  ds_swizzle_b32 v43, v19 offset:0x401f
  s_waitcnt lgkmcnt(0)
  v_add_f32 v16, v16, v40
  v_add_f32 v17, v17, v41
  v_add_f32 v18, v18, v42
  v_add_f32 v19, v19, v43
  v_mov_b32 v40, v16
  v_mov_b32 v41, v16
  s_nop 1
  v_permlane32_swap_b32 v40, v41
  s_nop 1
  v_add_f32 v16, v40, v41
  v_mov_b32 v40, v17
  v_mov_b32 v41, v17
  s_nop 1
  v_permlane32_swap_b32 v40, v41
  s_nop 1
  v_add_f32 v17, v40, v41
  v_mov_b32 v40, v18
  v_mov_b32 v41, v18
  s_nop 1
  v_permlane32_swap_b32 v40, v41
  s_nop 1
  v_add_f32 v18, v40, v41
  v_mov_b32 v40, v19
  v_mov_b32 v41, v19
  s_nop 1
  v_permlane32_swap_b32 v40, v41
  s_nop 1
  v_add_f32 v19, v40, v41
  v_cvt_pk_bf16_f32 v40, v16, v17
  v_cvt_pk_bf16_f32 v41, v18, v19
  s_lshl_b32 s66, s65, 11
  s_lshl_b32 s67, s64, 3
  s_add_u32 s66, s66, s67
  s_add_u32 s92, s38, s66
  s_addc_u32 s93, s39, 0
  s_add_u32 s92, s92, 1024
  s_addc_u32 s93, s93, 0
  s_mov_b64 exec, 1
  global_store_dwordx2 v4, v[40:41], s[92:93]
  s_mov_b64 exec, -1
  s_branch L_send
L_afinal:
  v_lshlrev_b32 v12, 12, v1
  s_lshl_b32 s66, s65, 11
  s_lshl_b32 s67, s64, 4
  s_add_u32 s66, s66, s67
  s_add_u32 s92, s42, s66
  s_addc_u32 s93, s43, 0
  s_add_u32 s92, s92, 196608
  s_addc_u32 s93, s93, 0
  s_barrier
  global_load_dwordx4 v[16:19], v12, s[92:93] sc1
  s_waitcnt vmcnt(0)
  s_nop 1
  v_add_f32_dpp v16, v16, v16 row_ror:8 row_mask:0xf bank_mask:0xf
  v_add_f32_dpp v17, v17, v17 row_ror:8 row_mask:0xf bank_mask:0xf
  v_add_f32_dpp v18, v18, v18 row_ror:8 row_mask:0xf bank_mask:0xf
  v_add_f32_dpp v19, v19, v19 row_ror:8 row_mask:0xf bank_mask:0xf
  v_add_f32_dpp v16, v16, v16 row_ror:4 row_mask:0xf bank_mask:0xf
  v_add_f32_dpp v17, v17, v17 row_ror:4 row_mask:0xf bank_mask:0xf
  v_add_f32_dpp v18, v18, v18 row_ror:4 row_mask:0xf bank_mask:0xf
  v_add_f32_dpp v19, v19, v19 row_ror:4 row_mask:0xf bank_mask:0xf
  v_add_f32_dpp v16, v16, v16 row_ror:2 row_mask:0xf bank_mask:0xf
  v_add_f32_dpp v17, v17, v17 row_ror:2 row_mask:0xf bank_mask:0xf
  v_add_f32_dpp v18, v18, v18 row_ror:2 row_mask:0xf bank_mask:0xf
  v_add_f32_dpp v19, v19, v19 row_ror:2 row_mask:0xf bank_mask:0xf
  v_add_f32_dpp v16, v16, v16 row_ror:1 row_mask:0xf bank_mask:0xf
  v_add_f32_dpp v17, v17, v17 row_ror:1 row_mask:0xf bank_mask:0xf
  v_add_f32_dpp v18, v18, v18 row_ror:1 row_mask:0xf bank_mask:0xf
  v_add_f32_dpp v19, v19, v19 row_ror:1 row_mask:0xf bank_mask:0xf
  ds_swizzle_b32 v40, v16 offset:0x401f
  ds_swizzle_b32 v41, v17 offset:0x401f
  ds_swizzle_b32 v42, v18 offset:0x401f
  ds_swizzle_b32 v43, v19 offset:0x401f
  s_waitcnt lgkmcnt(0)
  v_add_f32 v16, v16, v40
  v_add_f32 v17, v17, v41
  v_add_f32 v18, v18, v42
  v_add_f32 v19, v19, v43
  v_mov_b32 v40, v16
  v_mov_b32 v41, v16
  s_nop 1
  v_permlane32_swap_b32 v40, v41
  s_nop 1
  v_add_f32 v16, v40, v41
  v_mov_b32 v40, v17
  v_mov_b32 v41, v17
  s_nop 1
  v_permlane32_swap_b32 v40, v41
  s_nop 1
  v_add_f32 v17, v40, v41
  v_mov_b32 v40, v18
  v_mov_b32 v41, v18
  s_nop 1
  v_permlane32_swap_b32 v40, v41
  s_nop 1
  v_add_f32 v18, v40, v41
  v_mov_b32 v40, v19
  v_mov_b32 v41, v19
  s_nop 1
  v_permlane32_swap_b32 v40, v41
  s_nop 1
  v_add_f32 v19, v40, v41
  v_cvt_pk_bf16_f32 v40, v16, v17
  v_cvt_pk_bf16_f32 v41, v18, v19
  s_lshl_b32 s66, s65, 11
  s_lshl_b32 s67, s64, 3
  s_add_u32 s66, s66, s67
  s_add_u32 s92, s38, s66
  s_addc_u32 s93, s39, 0
  s_mov_b64 exec, 1
  global_store_dwordx2 v4, v[40:41], s[92:93]
  s_mov_b64 exec, -1
L_send:
  s_endpgm
L_bwg:
  s_sub_u32 s4, s2, 64
  s_lshr_b32 s4, s4, 3
  s_mul_i32 s5, s4, 43
  s_lshr_b32 s5, s5, 8
  s_add_u32 s44, s3, s5
  s_mul_i32 s5, s5, 6
  s_sub_u32 s4, s4, s5
  s_cmp_ge_u32 s4, 3
  s_cselect_b32 s46, 1, 0
  s_mul_i32 s5, s46, 3
  s_sub_u32 s47, s4, s5
  s_waitcnt lgkmcnt(0)
L_bprog:
  s_lshl_b32 s3, s46, 5
  s_add_u32 s3, s3, s44
  s_lshr_b32 s5, s3, 11
  s_lshl_b32 s4, s3, 21
  s_add_u32 s52, s30, s4
  s_addc_u32 s53, s31, s5
  s_and_b32 s53, s53, 0xffff
  s_mov_b32 s54, 0x200000
  s_mov_b32 s55, 0x20000
  s_add_u32 s56, s32, s4
  s_addc_u32 s57, s33, s5
  s_and_b32 s57, s57, 0xffff
  s_mov_b32 s58, 0x200000
  s_mov_b32 s59, 0x20000
  v_lshlrev_b32 v60, 10, v2
  v_lshl_add_u32 v60, v3, 4, v60
  v_add_u32 v61, 4096, v60
  s_mov_b32 s66, 0
  s_mov_b32 s70, 82
  s_cmp_eq_u32 s47, 1
  s_cselect_b32 s66, 82, s66
  s_cselect_b32 s70, 164, s70
  s_cmp_eq_u32 s47, 2
  s_cselect_b32 s66, 164, s66
  s_cselect_b32 s70, 246, s70
  s_cmp_eq_u32 s47, 3
  s_cselect_b32 s66, 246, s66
  s_cselect_b32 s70, 256, s70
  s_add_u32 s67, s66, 16
  v_mov_b32 v56, s67
  v_mov_b32 v57, 135168
  ds_write_b32 v57, v56
  v_mov_b32 v56, 1
  s_add_u32 s66, s66, s48
  s_lshl_b32 s74, s66, 13
  s_add_u32 s75, s74, 65536
  s_add_u32 s67, s66, 8
  s_cmp_lt_u32 s67, s70
  s_cselect_b32 s75, s75, 1073741824
  v_mov_b32 v24, 0
  v_mov_b32 v25, 0
  v_mov_b32 v26, 0
  v_mov_b32 v27, 0
  v_mov_b32 v28, 0
  v_mov_b32 v29, 0
  v_mov_b32 v30, 0
  v_mov_b32 v31, 0
  v_mov_b32 v32, 0xf149f2ca
  v_mov_b32 v33, 0
  v_lshlrev_b32 v7, 4, v1
  s_lshl_b32 s66, s44, 17
  s_add_u32 s60, s36, s66
  s_addc_u32 s61, s37, 0
  s_and_b32 s61, s61, 0xffff
  s_mov_b32 s62, 0x20000
  s_mov_b32 s63, 0x20000
  s_cmp_lt_u32 s2, 64
  s_cbranch_scc1 L_svc_entry
  v_lshlrev_b32 v42, 17, v2
  v_lshl_add_u32 v42, v3, 4, v42
  v_lshlrev_b32 v43, 5, v2
  s_lshl_b32 s66, s48, 7
  s_lshl_b32 s67, s46, 10
  s_add_u32 s66, s66, s67
  s_add_u32 s84, s28, s66
  s_addc_u32 s85, s29, 0
  global_load_dwordx4 v[8:11], v43, s[84:85] offset:0
  global_load_dwordx4 v[12:15], v43, s[84:85] offset:16
  s_lshl_b32 s66, s44, 8
  s_lshl_b32 s67, s48, 19
  s_add_u32 s66, s66, s67
  s_add_u32 s90, s34, s66
  s_addc_u32 s91, s35, 0
  global_load_dwordx4 v[192:195], v42, s[90:91] nt
  s_add_u32 s90, s90, 8192
  s_addc_u32 s91, s91, 0
  global_load_dwordx4 v[196:199], v42, s[90:91] nt
  s_add_u32 s90, s90, 8192
  s_addc_u32 s91, s91, 0
  global_load_dwordx4 v[200:203], v42, s[90:91] nt
  s_add_u32 s90, s90, 8192
  s_addc_u32 s91, s91, 0
  global_load_dwordx4 v[204:207], v42, s[90:91] nt
  s_add_u32 s90, s90, 8192
  s_addc_u32 s91, s91, 0
  global_load_dwordx4 v[208:211], v42, s[90:91] nt
  s_add_u32 s90, s90, 8192
  s_addc_u32 s91, s91, 0
  global_load_dwordx4 v[212:215], v42, s[90:91] nt
  s_add_u32 s90, s90, 8192
  s_addc_u32 s91, s91, 0
  global_load_dwordx4 v[216:219], v42, s[90:91] nt
  s_add_u32 s90, s90, 8192
  s_addc_u32 s91, s91, 0
  global_load_dwordx4 v[220:223], v42, s[90:91] nt
  s_add_u32 s90, s90, 8192
  s_addc_u32 s91, s91, 0
  global_load_dwordx4 v[224:227], v42, s[90:91] nt
  s_add_u32 s90, s90, 8192
  s_addc_u32 s91, s91, 0
  global_load_dwordx4 v[228:231], v42, s[90:91] nt
  s_add_u32 s90, s90, 8192
  s_addc_u32 s91, s91, 0
  global_load_dwordx4 v[232:235], v42, s[90:91] nt
  s_add_u32 s90, s90, 8192
  s_addc_u32 s91, s91, 0
  global_load_dwordx4 v[236:239], v42, s[90:91] nt
  s_add_u32 s90, s90, 8192
  s_addc_u32 s91, s91, 0
  global_load_dwordx4 v[240:243], v42, s[90:91] nt
  s_add_u32 s90, s90, 8192
  s_addc_u32 s91, s91, 0
  global_load_dwordx4 v[244:247], v42, s[90:91] nt
  s_add_u32 s90, s90, 8192
  s_addc_u32 s91, s91, 0
  global_load_dwordx4 v[248:251], v42, s[90:91] nt
  s_add_u32 s90, s90, 8192
  s_addc_u32 s91, s91, 0
  global_load_dwordx4 v[252:255], v42, s[90:91] nt
  s_barrier
  s_mov_b32 s73, s74
  buffer_load_dwordx4 v[64:67], v60, s[52:55], s73 offen offset:0 nt
  buffer_load_dwordx4 v[68:71], v60, s[52:55], s73 offen offset:256 nt
  buffer_load_dwordx4 v[72:75], v60, s[52:55], s73 offen offset:512 nt
  buffer_load_dwordx4 v[76:79], v60, s[52:55], s73 offen offset:768 nt
  buffer_load_dwordx4 v[80:83], v61, s[52:55], s73 offen offset:0 nt
  buffer_load_dwordx4 v[84:87], v61, s[52:55], s73 offen offset:256 nt
  buffer_load_dwordx4 v[88:91], v61, s[52:55], s73 offen offset:512 nt
  buffer_load_dwordx4 v[92:95], v61, s[52:55], s73 offen offset:768 nt
  buffer_load_dwordx4 v[96:99], v60, s[56:59], s73 offen offset:0 nt
  buffer_load_dwordx4 v[100:103], v60, s[56:59], s73 offen offset:256 nt
  buffer_load_dwordx4 v[104:107], v60, s[56:59], s73 offen offset:512 nt
  buffer_load_dwordx4 v[108:111], v60, s[56:59], s73 offen offset:768 nt
  buffer_load_dwordx4 v[112:115], v61, s[56:59], s73 offen offset:0 nt
  buffer_load_dwordx4 v[116:119], v61, s[56:59], s73 offen offset:256 nt
  buffer_load_dwordx4 v[120:123], v61, s[56:59], s73 offen offset:512 nt
  buffer_load_dwordx4 v[124:127], v61, s[56:59], s73 offen offset:768 nt
  v_mov_b32 v16, 0
  v_mov_b32 v17, 0
  v_mov_b32 v18, 0
  v_mov_b32 v19, 0
  v_mov_b32 v20, 0
  v_mov_b32 v21, 0
  v_mov_b32 v22, 0
  v_mov_b32 v23, 0
  s_waitcnt vmcnt(16)
  v_lshlrev_b32 v46, 16, v8
  v_lshlrev_b32 v44, 16, v192
  v_and_b32 v45, 0xffff0000, v192
  v_fmac_f32 v16, v46, v44
  v_fmac_f32 v17, v46, v45
  v_lshlrev_b32 v44, 16, v193
  v_and_b32 v45, 0xffff0000, v193
  v_fmac_f32 v18, v46, v44
  v_fmac_f32 v19, v46, v45
  v_lshlrev_b32 v44, 16, v194
  v_and_b32 v45, 0xffff0000, v194
  v_fmac_f32 v20, v46, v44
  v_fmac_f32 v21, v46, v45
  v_lshlrev_b32 v44, 16, v195
  v_and_b32 v45, 0xffff0000, v195
  v_fmac_f32 v22, v46, v44
  v_fmac_f32 v23, v46, v45
  v_and_b32 v46, 0xffff0000, v8
  v_lshlrev_b32 v44, 16, v196
  v_and_b32 v45, 0xffff0000, v196
  v_fmac_f32 v16, v46, v44
  v_fmac_f32 v17, v46, v45
  v_lshlrev_b32 v44, 16, v197
  v_and_b32 v45, 0xffff0000, v197
  v_fmac_f32 v18, v46, v44
  v_fmac_f32 v19, v46, v45
  v_lshlrev_b32 v44, 16, v198
  v_and_b32 v45, 0xffff0000, v198
  v_fmac_f32 v20, v46, v44
  v_fmac_f32 v21, v46, v45
  v_lshlrev_b32 v44, 16, v199
  v_and_b32 v45, 0xffff0000, v199
  v_fmac_f32 v22, v46, v44
  v_fmac_f32 v23, v46, v45
  v_lshlrev_b32 v46, 16, v9
  v_lshlrev_b32 v44, 16, v200
  v_and_b32 v45, 0xffff0000, v200
  v_fmac_f32 v16, v46, v44
  v_fmac_f32 v17, v46, v45
  v_lshlrev_b32 v44, 16, v201
  v_and_b32 v45, 0xffff0000, v201
  v_fmac_f32 v18, v46, v44
  v_fmac_f32 v19, v46, v45
  v_lshlrev_b32 v44, 16, v202
  v_and_b32 v45, 0xffff0000, v202
  v_fmac_f32 v20, v46, v44
  v_fmac_f32 v21, v46, v45
  v_lshlrev_b32 v44, 16, v203
  v_and_b32 v45, 0xffff0000, v203
  v_fmac_f32 v22, v46, v44
  v_fmac_f32 v23, v46, v45
  v_and_b32 v46, 0xffff0000, v9
  v_lshlrev_b32 v44, 16, v204
  v_and_b32 v45, 0xffff0000, v204
  v_fmac_f32 v16, v46, v44
  v_fmac_f32 v17, v46, v45
  v_lshlrev_b32 v44, 16, v205
  v_and_b32 v45, 0xffff0000, v205
  v_fmac_f32 v18, v46, v44
  v_fmac_f32 v19, v46, v45
  v_lshlrev_b32 v44, 16, v206
  v_and_b32 v45, 0xffff0000, v206
  v_fmac_f32 v20, v46, v44
  v_fmac_f32 v21, v46, v45
  v_lshlrev_b32 v44, 16, v207
  v_and_b32 v45, 0xffff0000, v207
  v_fmac_f32 v22, v46, v44
  v_fmac_f32 v23, v46, v45
  v_lshlrev_b32 v46, 16, v10
  v_lshlrev_b32 v44, 16, v208
  v_and_b32 v45, 0xffff0000, v208
  v_fmac_f32 v16, v46, v44
  v_fmac_f32 v17, v46, v45
  v_lshlrev_b32 v44, 16, v209
  v_and_b32 v45, 0xffff0000, v209
  v_fmac_f32 v18, v46, v44
  v_fmac_f32 v19, v46, v45
  v_lshlrev_b32 v44, 16, v210
  v_and_b32 v45, 0xffff0000, v210
  v_fmac_f32 v20, v46, v44
  v_fmac_f32 v21, v46, v45
  v_lshlrev_b32 v44, 16, v211
  v_and_b32 v45, 0xffff0000, v211
  v_fmac_f32 v22, v46, v44
  v_fmac_f32 v23, v46, v45
  v_and_b32 v46, 0xffff0000, v10
  v_lshlrev_b32 v44, 16, v212
  v_and_b32 v45, 0xffff0000, v212
  v_fmac_f32 v16, v46, v44
  v_fmac_f32 v17, v46, v45
  v_lshlrev_b32 v44, 16, v213
  v_and_b32 v45, 0xffff0000, v213
  v_fmac_f32 v18, v46, v44
  v_fmac_f32 v19, v46, v45
  v_lshlrev_b32 v44, 16, v214
  v_and_b32 v45, 0xffff0000, v214
  v_fmac_f32 v20, v46, v44
  v_fmac_f32 v21, v46, v45
  v_lshlrev_b32 v44, 16, v215
  v_and_b32 v45, 0xffff0000, v215
  v_fmac_f32 v22, v46, v44
  v_fmac_f32 v23, v46, v45
  v_lshlrev_b32 v46, 16, v11
  v_lshlrev_b32 v44, 16, v216
  v_and_b32 v45, 0xffff0000, v216
  v_fmac_f32 v16, v46, v44
  v_fmac_f32 v17, v46, v45
  v_lshlrev_b32 v44, 16, v217
  v_and_b32 v45, 0xffff0000, v217
  v_fmac_f32 v18, v46, v44
  v_fmac_f32 v19, v46, v45
  v_lshlrev_b32 v44, 16, v218
  v_and_b32 v45, 0xffff0000, v218
  v_fmac_f32 v20, v46, v44
  v_fmac_f32 v21, v46, v45
  v_lshlrev_b32 v44, 16, v219
  v_and_b32 v45, 0xffff0000, v219
  v_fmac_f32 v22, v46, v44
  v_fmac_f32 v23, v46, v45
  v_and_b32 v46, 0xffff0000, v11
  v_lshlrev_b32 v44, 16, v220
  v_and_b32 v45, 0xffff0000, v220
  v_fmac_f32 v16, v46, v44
  v_fmac_f32 v17, v46, v45
  v_lshlrev_b32 v44, 16, v221
  v_and_b32 v45, 0xffff0000, v221
  v_fmac_f32 v18, v46, v44
  v_fmac_f32 v19, v46, v45
  v_lshlrev_b32 v44, 16, v222
  v_and_b32 v45, 0xffff0000, v222
  v_fmac_f32 v20, v46, v44
  v_fmac_f32 v21, v46, v45
  v_lshlrev_b32 v44, 16, v223
  v_and_b32 v45, 0xffff0000, v223
  v_fmac_f32 v22, v46, v44
  v_fmac_f32 v23, v46, v45
  v_lshlrev_b32 v46, 16, v12
  v_lshlrev_b32 v44, 16, v224
  v_and_b32 v45, 0xffff0000, v224
  v_fmac_f32 v16, v46, v44
  v_fmac_f32 v17, v46, v45
  v_lshlrev_b32 v44, 16, v225
  v_and_b32 v45, 0xffff0000, v225
  v_fmac_f32 v18, v46, v44
  v_fmac_f32 v19, v46, v45
  v_lshlrev_b32 v44, 16, v226
  v_and_b32 v45, 0xffff0000, v226
  v_fmac_f32 v20, v46, v44
  v_fmac_f32 v21, v46, v45
  v_lshlrev_b32 v44, 16, v227
  v_and_b32 v45, 0xffff0000, v227
  v_fmac_f32 v22, v46, v44
  v_fmac_f32 v23, v46, v45
  v_and_b32 v46, 0xffff0000, v12
  v_lshlrev_b32 v44, 16, v228
  v_and_b32 v45, 0xffff0000, v228
  v_fmac_f32 v16, v46, v44
  v_fmac_f32 v17, v46, v45
  v_lshlrev_b32 v44, 16, v229
  v_and_b32 v45, 0xffff0000, v229
  v_fmac_f32 v18, v46, v44
  v_fmac_f32 v19, v46, v45
  v_lshlrev_b32 v44, 16, v230
  v_and_b32 v45, 0xffff0000, v230
  v_fmac_f32 v20, v46, v44
  v_fmac_f32 v21, v46, v45
  v_lshlrev_b32 v44, 16, v231
  v_and_b32 v45, 0xffff0000, v231
  v_fmac_f32 v22, v46, v44
  v_fmac_f32 v23, v46, v45
  v_lshlrev_b32 v46, 16, v13
  v_lshlrev_b32 v44, 16, v232
  v_and_b32 v45, 0xffff0000, v232
  v_fmac_f32 v16, v46, v44
  v_fmac_f32 v17, v46, v45
  v_lshlrev_b32 v44, 16, v233
  v_and_b32 v45, 0xffff0000, v233
  v_fmac_f32 v18, v46, v44
  v_fmac_f32 v19, v46, v45
  v_lshlrev_b32 v44, 16, v234
  v_and_b32 v45, 0xffff0000, v234
  v_fmac_f32 v20, v46, v44
  v_fmac_f32 v21, v46, v45
  v_lshlrev_b32 v44, 16, v235
  v_and_b32 v45, 0xffff0000, v235
  v_fmac_f32 v22, v46, v44
  v_fmac_f32 v23, v46, v45
  v_and_b32 v46, 0xffff0000, v13
  v_lshlrev_b32 v44, 16, v236
  v_and_b32 v45, 0xffff0000, v236
  v_fmac_f32 v16, v46, v44
  v_fmac_f32 v17, v46, v45
  v_lshlrev_b32 v44, 16, v237
  v_and_b32 v45, 0xffff0000, v237
  v_fmac_f32 v18, v46, v44
  v_fmac_f32 v19, v46, v45
  v_lshlrev_b32 v44, 16, v238
  v_and_b32 v45, 0xffff0000, v238
  v_fmac_f32 v20, v46, v44
  v_fmac_f32 v21, v46, v45
  v_lshlrev_b32 v44, 16, v239
  v_and_b32 v45, 0xffff0000, v239
  v_fmac_f32 v22, v46, v44
  v_fmac_f32 v23, v46, v45
  v_lshlrev_b32 v46, 16, v14
  v_lshlrev_b32 v44, 16, v240
  v_and_b32 v45, 0xffff0000, v240
  v_fmac_f32 v16, v46, v44
  v_fmac_f32 v17, v46, v45
  v_lshlrev_b32 v44, 16, v241
  v_and_b32 v45, 0xffff0000, v241
  v_fmac_f32 v18, v46, v44
  v_fmac_f32 v19, v46, v45
  v_lshlrev_b32 v44, 16, v242
  v_and_b32 v45, 0xffff0000, v242
  v_fmac_f32 v20, v46, v44
  v_fmac_f32 v21, v46, v45
  v_lshlrev_b32 v44, 16, v243
  v_and_b32 v45, 0xffff0000, v243
  v_fmac_f32 v22, v46, v44
  v_fmac_f32 v23, v46, v45
  v_and_b32 v46, 0xffff0000, v14
  v_lshlrev_b32 v44, 16, v244
  v_and_b32 v45, 0xffff0000, v244
  v_fmac_f32 v16, v46, v44
  v_fmac_f32 v17, v46, v45
  v_lshlrev_b32 v44, 16, v245
  v_and_b32 v45, 0xffff0000, v245
  v_fmac_f32 v18, v46, v44
  v_fmac_f32 v19, v46, v45
  v_lshlrev_b32 v44, 16, v246
  v_and_b32 v45, 0xffff0000, v246
  v_fmac_f32 v20, v46, v44
  v_fmac_f32 v21, v46, v45
  v_lshlrev_b32 v44, 16, v247
  v_and_b32 v45, 0xffff0000, v247
  v_fmac_f32 v22, v46, v44
  v_fmac_f32 v23, v46, v45
  v_lshlrev_b32 v46, 16, v15
  v_lshlrev_b32 v44, 16, v248
  v_and_b32 v45, 0xffff0000, v248
  v_fmac_f32 v16, v46, v44
  v_fmac_f32 v17, v46, v45
  v_lshlrev_b32 v44, 16, v249
  v_and_b32 v45, 0xffff0000, v249
  v_fmac_f32 v18, v46, v44
  v_fmac_f32 v19, v46, v45
  v_lshlrev_b32 v44, 16, v250
  v_and_b32 v45, 0xffff0000, v250
  v_fmac_f32 v20, v46, v44
  v_fmac_f32 v21, v46, v45
  v_lshlrev_b32 v44, 16, v251
  v_and_b32 v45, 0xffff0000, v251
  v_fmac_f32 v22, v46, v44
  v_fmac_f32 v23, v46, v45
  v_and_b32 v46, 0xffff0000, v15
  v_lshlrev_b32 v44, 16, v252
  v_and_b32 v45, 0xffff0000, v252
  v_fmac_f32 v16, v46, v44
  v_fmac_f32 v17, v46, v45
  v_lshlrev_b32 v44, 16, v253
  v_and_b32 v45, 0xffff0000, v253
  v_fmac_f32 v18, v46, v44
  v_fmac_f32 v19, v46, v45
  v_lshlrev_b32 v44, 16, v254
  v_and_b32 v45, 0xffff0000, v254
  v_fmac_f32 v20, v46, v44
  v_fmac_f32 v21, v46, v45
  v_lshlrev_b32 v44, 16, v255
  v_and_b32 v45, 0xffff0000, v255
  v_fmac_f32 v22, v46, v44
  v_fmac_f32 v23, v46, v45
  ds_swizzle_b32 v44, v16 offset:0x401f
  ds_swizzle_b32 v45, v17 offset:0x401f
  ds_swizzle_b32 v46, v18 offset:0x401f
  ds_swizzle_b32 v47, v19 offset:0x401f
  ds_swizzle_b32 v48, v20 offset:0x401f
  ds_swizzle_b32 v49, v21 offset:0x401f
  ds_swizzle_b32 v50, v22 offset:0x401f
  ds_swizzle_b32 v51, v23 offset:0x401f
  s_waitcnt lgkmcnt(0)
  v_add_f32 v16, v16, v44
  v_add_f32 v17, v17, v45
  v_add_f32 v18, v18, v46
  v_add_f32 v19, v19, v47
  v_add_f32 v20, v20, v48
  v_add_f32 v21, v21, v49
  v_add_f32 v22, v22, v50
  v_add_f32 v23, v23, v51
  v_mov_b32 v44, v16
  v_mov_b32 v45, v16
  s_nop 1
  v_permlane32_swap_b32 v44, v45
  s_nop 1
  v_add_f32 v16, v44, v45
  v_mov_b32 v44, v17
  v_mov_b32 v45, v17
  s_nop 1
  v_permlane32_swap_b32 v44, v45
  s_nop 1
  v_add_f32 v17, v44, v45
  v_mov_b32 v44, v18
  v_mov_b32 v45, v18
  s_nop 1
  v_permlane32_swap_b32 v44, v45
  s_nop 1
  v_add_f32 v18, v44, v45
  v_mov_b32 v44, v19
  v_mov_b32 v45, v19
  s_nop 1
  v_permlane32_swap_b32 v44, v45
  s_nop 1
  v_add_f32 v19, v44, v45
  v_mov_b32 v44, v20
  v_mov_b32 v45, v20
  s_nop 1
  v_permlane32_swap_b32 v44, v45
  s_nop 1
  v_add_f32 v20, v44, v45
  v_mov_b32 v44, v21
  v_mov_b32 v45, v21
  s_nop 1
  v_permlane32_swap_b32 v44, v45
  s_nop 1
  v_add_f32 v21, v44, v45
  v_mov_b32 v44, v22
  v_mov_b32 v45, v22
  s_nop 1
  v_permlane32_swap_b32 v44, v45
  s_nop 1
  v_add_f32 v22, v44, v45
  v_mov_b32 v44, v23
  v_mov_b32 v45, v23
  s_nop 1
  v_permlane32_swap_b32 v44, v45
  s_nop 1
  v_add_f32 v23, v44, v45
  s_lshl_b32 s66, s48, 9
  s_add_u32 s66, s66, 135424
  v_lshlrev_b32 v42, 5, v3
  v_add_u32 v43, s66, v42
  s_mov_b64 exec, 0xffff
  ds_write_b128 v43, v[16:19]
  ds_write_b128 v43, v[20:23] offset:16
  s_mov_b64 exec, -1
  s_waitcnt lgkmcnt(0)
  s_barrier
  s_mov_b32 s73, s75
  buffer_load_dwordx4 v[128:131], v60, s[52:55], s73 offen offset:0 nt
  buffer_load_dwordx4 v[132:135], v60, s[52:55], s73 offen offset:256 nt
  buffer_load_dwordx4 v[136:139], v60, s[52:55], s73 offen offset:512 nt
  buffer_load_dwordx4 v[140:143], v60, s[52:55], s73 offen offset:768 nt
  buffer_load_dwordx4 v[144:147], v61, s[52:55], s73 offen offset:0 nt
  buffer_load_dwordx4 v[148:151], v61, s[52:55], s73 offen offset:256 nt
  buffer_load_dwordx4 v[152:155], v61, s[52:55], s73 offen offset:512 nt
  buffer_load_dwordx4 v[156:159], v61, s[52:55], s73 offen offset:768 nt
  buffer_load_dwordx4 v[160:163], v60, s[56:59], s73 offen offset:0 nt
  buffer_load_dwordx4 v[164:167], v60, s[56:59], s73 offen offset:256 nt
  buffer_load_dwordx4 v[168:171], v60, s[56:59], s73 offen offset:512 nt
  buffer_load_dwordx4 v[172:175], v60, s[56:59], s73 offen offset:768 nt
  buffer_load_dwordx4 v[176:179], v61, s[56:59], s73 offen offset:0 nt
  buffer_load_dwordx4 v[180:183], v61, s[56:59], s73 offen offset:256 nt
  buffer_load_dwordx4 v[184:187], v61, s[56:59], s73 offen offset:512 nt
  buffer_load_dwordx4 v[188:191], v61, s[56:59], s73 offen offset:768 nt
  v_add_u32 v42, 135424, v42
  ds_read_b128 v[192:195], v42 offset:0
  ds_read_b128 v[196:199], v42 offset:16
  ds_read_b128 v[200:203], v42 offset:512
  ds_read_b128 v[204:207], v42 offset:528
  ds_read_b128 v[208:211], v42 offset:1024
  ds_read_b128 v[212:215], v42 offset:1040
  ds_read_b128 v[216:219], v42 offset:1536
  ds_read_b128 v[220:223], v42 offset:1552
  ds_read_b128 v[224:227], v42 offset:2048
  ds_read_b128 v[228:231], v42 offset:2064
  ds_read_b128 v[232:235], v42 offset:2560
  ds_read_b128 v[236:239], v42 offset:2576
  ds_read_b128 v[240:243], v42 offset:3072
  ds_read_b128 v[244:247], v42 offset:3088
  ds_read_b128 v[248:251], v42 offset:3584
  ds_read_b128 v[252:255], v42 offset:3600
  s_waitcnt lgkmcnt(0)
  v_add_f32 v192, v192, v200
  v_add_f32 v193, v193, v201
  v_add_f32 v194, v194, v202
  v_add_f32 v195, v195, v203
  v_add_f32 v196, v196, v204
  v_add_f32 v197, v197, v205
  v_add_f32 v198, v198, v206
  v_add_f32 v199, v199, v207
  v_add_f32 v192, v192, v208
  v_add_f32 v193, v193, v209
  v_add_f32 v194, v194, v210
  v_add_f32 v195, v195, v211
  v_add_f32 v196, v196, v212
  v_add_f32 v197, v197, v213
  v_add_f32 v198, v198, v214
  v_add_f32 v199, v199, v215
  v_add_f32 v192, v192, v216
  v_add_f32 v193, v193, v217
  v_add_f32 v194, v194, v218
  v_add_f32 v195, v195, v219
  v_add_f32 v196, v196, v220
  v_add_f32 v197, v197, v221
  v_add_f32 v198, v198, v222
  v_add_f32 v199, v199, v223
  v_add_f32 v192, v192, v224
  v_add_f32 v193, v193, v225
  v_add_f32 v194, v194, v226
  v_add_f32 v195, v195, v227
  v_add_f32 v196, v196, v228
  v_add_f32 v197, v197, v229
  v_add_f32 v198, v198, v230
  v_add_f32 v199, v199, v231
  v_add_f32 v192, v192, v232
  v_add_f32 v193, v193, v233
  v_add_f32 v194, v194, v234
  v_add_f32 v195, v195, v235
  v_add_f32 v196, v196, v236
  v_add_f32 v197, v197, v237
  v_add_f32 v198, v198, v238
  v_add_f32 v199, v199, v239
  v_add_f32 v192, v192, v240
  v_add_f32 v193, v193, v241
  v_add_f32 v194, v194, v242
  v_add_f32 v195, v195, v243
  v_add_f32 v196, v196, v244
  v_add_f32 v197, v197, v245
  v_add_f32 v198, v198, v246
  v_add_f32 v199, v199, v247
  v_add_f32 v192, v192, v248
  v_add_f32 v193, v193, v249
  v_add_f32 v194, v194, v250
  v_add_f32 v195, v195, v251
  v_add_f32 v196, v196, v252
  v_add_f32 v197, v197, v253
  v_add_f32 v198, v198, v254
  v_add_f32 v199, v199, v255
  v_cvt_pk_bf16_f32 v8, v192, v193
  v_cvt_pk_bf16_f32 v9, v194, v195
  v_cvt_pk_bf16_f32 v10, v196, v197
  v_cvt_pk_bf16_f32 v11, v198, v199
  s_add_u32 s66, s47, s48
  s_cmp_eq_u32 s66, 0
  s_cbranch_scc0 L_npq_20
  s_lshl_b32 s66, s44, 9
  s_lshl_b32 s67, s46, 8
  s_add_u32 s66, s66, s67
  s_add_u32 s90, s42, s66
  s_addc_u32 s91, s43, 0
  v_lshlrev_b32 v42, 4, v3
  s_mov_b64 exec, 0xffff
  global_store_dwordx4 v42, v[8:11], s[90:91] sc1
  s_mov_b64 exec, -1
  s_waitcnt vmcnt(0)
  s_lshl_b32 s66, s46, 2
  s_add_u32 s90, s40, s66
  s_addc_u32 s91, s41, 0
  s_add_u32 s90, s90, 64
  s_addc_u32 s91, s91, 0
  s_lshl_b32 s66, 1, s44
  s_mov_b64 exec, 1
  v_mov_b32 v42, s66
  global_atomic_or v4, v42, s[90:91] sc1
  s_mov_b64 exec, -1
  s_waitcnt vmcnt(0)
L_npq_20:
  s_mov_b32 s76, 0
  s_cmp_eq_u32 s74, 1073741824
  s_cbranch_scc1 L_bdone
  s_mov_b64 exec, 1
  ds_add_rtn_u32 v42, v57, v56
  s_mov_b64 exec, -1
  s_waitcnt vmcnt(24)
  v_dot2_f32_bf16 v34, v64, v8, 0
  v_dot2_f32_bf16 v35, v68, v8, 0
  v_dot2_f32_bf16 v36, v72, v8, 0
  v_dot2_f32_bf16 v37, v76, v8, 0
  v_dot2_f32_bf16 v38, v80, v8, 0
  v_dot2_f32_bf16 v39, v84, v8, 0
  v_dot2_f32_bf16 v40, v88, v8, 0
  v_dot2_f32_bf16 v41, v92, v8, 0
  v_dot2_f32_bf16 v34, v65, v9, v34
  v_dot2_f32_bf16 v35, v69, v9, v35
  v_dot2_f32_bf16 v36, v73, v9, v36
  v_dot2_f32_bf16 v37, v77, v9, v37
  v_dot2_f32_bf16 v38, v81, v9, v38
  v_dot2_f32_bf16 v39, v85, v9, v39
  v_dot2_f32_bf16 v40, v89, v9, v40
  v_dot2_f32_bf16 v41, v93, v9, v41
  v_dot2_f32_bf16 v34, v66, v10, v34
  v_dot2_f32_bf16 v35, v70, v10, v35
  v_dot2_f32_bf16 v36, v74, v10, v36
  v_dot2_f32_bf16 v37, v78, v10, v37
  v_dot2_f32_bf16 v38, v82, v10, v38
  v_dot2_f32_bf16 v39, v86, v10, v39
  v_dot2_f32_bf16 v40, v90, v10, v40
  v_dot2_f32_bf16 v41, v94, v10, v41
  v_dot2_f32_bf16 v34, v67, v11, v34
  v_dot2_f32_bf16 v35, v71, v11, v35
  v_dot2_f32_bf16 v36, v75, v11, v36
  v_dot2_f32_bf16 v37, v79, v11, v37
  v_dot2_f32_bf16 v38, v83, v11, v38
  v_dot2_f32_bf16 v39, v87, v11, v39
  v_dot2_f32_bf16 v40, v91, v11, v40
  v_dot2_f32_bf16 v41, v95, v11, v41
  s_waitcnt lgkmcnt(0)
  v_readfirstlane_b32 s66, v42
  s_lshl_b32 s67, s66, 13
  s_cmp_lt_u32 s66, s70
  s_cselect_b32 s73, s67, 1073741824
  s_mov_b32 s74, s73
  buffer_load_dwordx4 v[64:67], v60, s[52:55], s73 offen offset:0 nt
  buffer_load_dwordx4 v[68:71], v60, s[52:55], s73 offen offset:256 nt
  buffer_load_dwordx4 v[72:75], v60, s[52:55], s73 offen offset:512 nt
  buffer_load_dwordx4 v[76:79], v60, s[52:55], s73 offen offset:768 nt
  buffer_load_dwordx4 v[80:83], v61, s[52:55], s73 offen offset:0 nt
  buffer_load_dwordx4 v[84:87], v61, s[52:55], s73 offen offset:256 nt
  buffer_load_dwordx4 v[88:91], v61, s[52:55], s73 offen offset:512 nt
  buffer_load_dwordx4 v[92:95], v61, s[52:55], s73 offen offset:768 nt
  s_lshl_b32 s67, s48, 14
  s_mul_i32 s68, s48, 16896
  s_mov_b32 m0, s68
  s_add_u32 s68, s68, 1056
  buffer_load_dwordx4 v7, s[60:63], s67 offen nt lds
  s_add_u32 s67, s67, 1024
  s_mov_b32 m0, s68
  s_add_u32 s68, s68, 1056
  buffer_load_dwordx4 v7, s[60:63], s67 offen nt lds
  s_add_u32 s67, s67, 1024
  s_mov_b32 m0, s68
  s_add_u32 s68, s68, 1056
  buffer_load_dwordx4 v7, s[60:63], s67 offen nt lds
  s_add_u32 s67, s67, 1024
  s_mov_b32 m0, s68
  s_add_u32 s68, s68, 1056
  buffer_load_dwordx4 v7, s[60:63], s67 offen nt lds
  s_add_u32 s67, s67, 1024
  s_mov_b32 m0, s68
  s_add_u32 s68, s68, 1056
  buffer_load_dwordx4 v7, s[60:63], s67 offen nt lds
  s_add_u32 s67, s67, 1024
  s_mov_b32 m0, s68
  s_add_u32 s68, s68, 1056
  buffer_load_dwordx4 v7, s[60:63], s67 offen nt lds
  s_add_u32 s67, s67, 1024
  s_mov_b32 m0, s68
  s_add_u32 s68, s68, 1056
  buffer_load_dwordx4 v7, s[60:63], s67 offen nt lds
  s_add_u32 s67, s67, 1024
  s_mov_b32 m0, s68
  s_add_u32 s68, s68, 1056
  buffer_load_dwordx4 v7, s[60:63], s67 offen nt lds
  s_add_u32 s67, s67, 1024
  s_mov_b32 m0, s68
  s_add_u32 s68, s68, 1056
  buffer_load_dwordx4 v7, s[60:63], s67 offen nt lds
  s_add_u32 s67, s67, 1024
  s_mov_b32 m0, s68
  s_add_u32 s68, s68, 1056
  buffer_load_dwordx4 v7, s[60:63], s67 offen nt lds
  s_add_u32 s67, s67, 1024
  s_mov_b32 m0, s68
  s_add_u32 s68, s68, 1056
  buffer_load_dwordx4 v7, s[60:63], s67 offen nt lds
  s_add_u32 s67, s67, 1024
  s_mov_b32 m0, s68
  s_add_u32 s68, s68, 1056
  buffer_load_dwordx4 v7, s[60:63], s67 offen nt lds
  s_add_u32 s67, s67, 1024
  s_mov_b32 m0, s68
  s_add_u32 s68, s68, 1056
  buffer_load_dwordx4 v7, s[60:63], s67 offen nt lds
  s_add_u32 s67, s67, 1024
  s_mov_b32 m0, s68
  s_add_u32 s68, s68, 1056
  buffer_load_dwordx4 v7, s[60:63], s67 offen nt lds
  s_add_u32 s67, s67, 1024
  s_mov_b32 m0, s68
  s_add_u32 s68, s68, 1056
  buffer_load_dwordx4 v7, s[60:63], s67 offen nt lds
  s_add_u32 s67, s67, 1024
  s_mov_b32 m0, s68
  s_add_u32 s68, s68, 1056
  buffer_load_dwordx4 v7, s[60:63], s67 offen nt lds
  s_add_u32 s67, s67, 1024
  v_add_f32_dpp v34, v34, v34 row_ror:8 row_mask:0xf bank_mask:0xf
  v_add_f32_dpp v35, v35, v35 row_ror:8 row_mask:0xf bank_mask:0xf
  v_add_f32_dpp v36, v36, v36 row_ror:8 row_mask:0xf bank_mask:0xf
  v_add_f32_dpp v37, v37, v37 row_ror:8 row_mask:0xf bank_mask:0xf
  v_add_f32_dpp v38, v38, v38 row_ror:8 row_mask:0xf bank_mask:0xf
  v_add_f32_dpp v39, v39, v39 row_ror:8 row_mask:0xf bank_mask:0xf
  v_add_f32_dpp v40, v40, v40 row_ror:8 row_mask:0xf bank_mask:0xf
  v_add_f32_dpp v41, v41, v41 row_ror:8 row_mask:0xf bank_mask:0xf
  v_add_f32_dpp v34, v34, v34 row_ror:4 row_mask:0xf bank_mask:0xf
  v_add_f32_dpp v35, v35, v35 row_ror:4 row_mask:0xf bank_mask:0xf
  v_add_f32_dpp v36, v36, v36 row_ror:4 row_mask:0xf bank_mask:0xf
  v_add_f32_dpp v37, v37, v37 row_ror:4 row_mask:0xf bank_mask:0xf
  v_add_f32_dpp v38, v38, v38 row_ror:4 row_mask:0xf bank_mask:0xf
  v_add_f32_dpp v39, v39, v39 row_ror:4 row_mask:0xf bank_mask:0xf
  v_add_f32_dpp v40, v40, v40 row_ror:4 row_mask:0xf bank_mask:0xf
  v_add_f32_dpp v41, v41, v41 row_ror:4 row_mask:0xf bank_mask:0xf
  v_add_f32_dpp v34, v34, v34 row_ror:2 row_mask:0xf bank_mask:0xf
  v_add_f32_dpp v35, v35, v35 row_ror:2 row_mask:0xf bank_mask:0xf
  v_add_f32_dpp v36, v36, v36 row_ror:2 row_mask:0xf bank_mask:0xf
  v_add_f32_dpp v37, v37, v37 row_ror:2 row_mask:0xf bank_mask:0xf
  v_add_f32_dpp v38, v38, v38 row_ror:2 row_mask:0xf bank_mask:0xf
  v_add_f32_dpp v39, v39, v39 row_ror:2 row_mask:0xf bank_mask:0xf
  v_add_f32_dpp v40, v40, v40 row_ror:2 row_mask:0xf bank_mask:0xf
  v_add_f32_dpp v41, v41, v41 row_ror:2 row_mask:0xf bank_mask:0xf
  v_add_f32_dpp v34, v34, v34 row_ror:1 row_mask:0xf bank_mask:0xf
  v_add_f32_dpp v35, v35, v35 row_ror:1 row_mask:0xf bank_mask:0xf
  v_add_f32_dpp v36, v36, v36 row_ror:1 row_mask:0xf bank_mask:0xf
  v_add_f32_dpp v37, v37, v37 row_ror:1 row_mask:0xf bank_mask:0xf
  v_add_f32_dpp v38, v38, v38 row_ror:1 row_mask:0xf bank_mask:0xf
  v_add_f32_dpp v39, v39, v39 row_ror:1 row_mask:0xf bank_mask:0xf
  v_add_f32_dpp v40, v40, v40 row_ror:1 row_mask:0xf bank_mask:0xf
  v_add_f32_dpp v41, v41, v41 row_ror:1 row_mask:0xf bank_mask:0xf
  v_cvt_pk_bf16_f32 v50, v34, v35
  v_lshlrev_b32 v42, 16, v50
  v_and_b32 v43, 0xffff0000, v50
  v_mul_f32 v42, s81, v42
  v_mul_f32 v43, s81, v43
  v_cvt_pk_bf16_f32 v50, v42, v43
  v_lshlrev_b32 v42, 16, v50
  v_and_b32 v43, 0xffff0000, v50
  v_cvt_pk_bf16_f32 v50, v36, v37
  v_lshlrev_b32 v44, 16, v50
  v_and_b32 v45, 0xffff0000, v50
  v_mul_f32 v44, s81, v44
  v_mul_f32 v45, s81, v45
  v_cvt_pk_bf16_f32 v50, v44, v45
  v_lshlrev_b32 v44, 16, v50
  v_and_b32 v45, 0xffff0000, v50
  v_cvt_pk_bf16_f32 v50, v38, v39
  v_lshlrev_b32 v46, 16, v50
  v_and_b32 v47, 0xffff0000, v50
  v_mul_f32 v46, s81, v46
  v_mul_f32 v47, s81, v47
  v_cvt_pk_bf16_f32 v50, v46, v47
  v_lshlrev_b32 v46, 16, v50
  v_and_b32 v47, 0xffff0000, v50
  v_cvt_pk_bf16_f32 v50, v40, v41
  v_lshlrev_b32 v48, 16, v50
  v_and_b32 v49, 0xffff0000, v50
  v_mul_f32 v48, s81, v48
  v_mul_f32 v49, s81, v49
  v_cvt_pk_bf16_f32 v50, v48, v49
  v_lshlrev_b32 v48, 16, v50
  v_and_b32 v49, 0xffff0000, v50
  v_max3_f32 v50, v42, v43, v44
  v_max3_f32 v51, v45, v46, v47
  v_max3_f32 v52, v48, v49, v32
  v_max3_f32 v50, v50, v51, v52
  v_sub_f32 v51, v32, v50
  v_mul_f32 v51, s80, v51
  v_exp_f32 v51, v51
  v_mov_b32 v32, v50
  v_sub_f32 v42, v42, v50
  v_sub_f32 v43, v43, v50
  v_sub_f32 v44, v44, v50
  v_sub_f32 v45, v45, v50
  v_sub_f32 v46, v46, v50
  v_sub_f32 v47, v47, v50
  v_sub_f32 v48, v48, v50
  v_sub_f32 v49, v49, v50
  v_mul_f32 v42, s80, v42
  v_mul_f32 v43, s80, v43
  v_mul_f32 v44, s80, v44
  v_mul_f32 v45, s80, v45
  v_mul_f32 v46, s80, v46
  v_mul_f32 v47, s80, v47
  v_mul_f32 v48, s80, v48
  v_mul_f32 v49, s80, v49
  v_exp_f32 v42, v42
  v_exp_f32 v43, v43
  v_exp_f32 v44, v44
  v_exp_f32 v45, v45
  v_exp_f32 v46, v46
  v_exp_f32 v47, v47
  v_exp_f32 v48, v48
  v_exp_f32 v49, v49
  v_mul_f32 v33, v33, v51
  v_mul_f32 v24, v24, v51
  v_mul_f32 v25, v25, v51
  v_mul_f32 v26, v26, v51
  v_mul_f32 v27, v27, v51
  v_mul_f32 v28, v28, v51
  v_mul_f32 v29, v29, v51
  v_mul_f32 v30, v30, v51
  v_mul_f32 v31, v31, v51
  v_add_f32 v52, v42, v43
  v_add_f32 v53, v44, v45
  v_add_f32 v54, v46, v47
  v_add_f32 v55, v48, v49
  v_add_f32 v52, v52, v53
  v_add_f32 v54, v54, v55
  v_add_f32 v52, v52, v54
  v_add_f32 v33, v33, v52
  s_waitcnt vmcnt(40)
  v_lshlrev_b32 v52, 16, v96
  v_and_b32 v53, 0xffff0000, v96
  v_fmac_f32 v24, v42, v52
  v_fmac_f32 v25, v42, v53
  v_lshlrev_b32 v52, 16, v97
  v_and_b32 v53, 0xffff0000, v97
  v_fmac_f32 v26, v42, v52
  v_fmac_f32 v27, v42, v53
  v_lshlrev_b32 v52, 16, v98
  v_and_b32 v53, 0xffff0000, v98
  v_fmac_f32 v28, v42, v52
  v_fmac_f32 v29, v42, v53
  v_lshlrev_b32 v52, 16, v99
  v_and_b32 v53, 0xffff0000, v99
  v_fmac_f32 v30, v42, v52
  v_fmac_f32 v31, v42, v53
  v_lshlrev_b32 v52, 16, v100
  v_and_b32 v53, 0xffff0000, v100
  v_fmac_f32 v24, v43, v52
  v_fmac_f32 v25, v43, v53
  v_lshlrev_b32 v52, 16, v101
  v_and_b32 v53, 0xffff0000, v101
  v_fmac_f32 v26, v43, v52
  v_fmac_f32 v27, v43, v53
  v_lshlrev_b32 v52, 16, v102
  v_and_b32 v53, 0xffff0000, v102
  v_fmac_f32 v28, v43, v52
  v_fmac_f32 v29, v43, v53
  v_lshlrev_b32 v52, 16, v103
  v_and_b32 v53, 0xffff0000, v103
  v_fmac_f32 v30, v43, v52
  v_fmac_f32 v31, v43, v53
  v_lshlrev_b32 v52, 16, v104
  v_and_b32 v53, 0xffff0000, v104
  v_fmac_f32 v24, v44, v52
  v_fmac_f32 v25, v44, v53
  v_lshlrev_b32 v52, 16, v105
  v_and_b32 v53, 0xffff0000, v105
  v_fmac_f32 v26, v44, v52
  v_fmac_f32 v27, v44, v53
  v_lshlrev_b32 v52, 16, v106
  v_and_b32 v53, 0xffff0000, v106
  v_fmac_f32 v28, v44, v52
  v_fmac_f32 v29, v44, v53
  v_lshlrev_b32 v52, 16, v107
  v_and_b32 v53, 0xffff0000, v107
  v_fmac_f32 v30, v44, v52
  v_fmac_f32 v31, v44, v53
  v_lshlrev_b32 v52, 16, v108
  v_and_b32 v53, 0xffff0000, v108
  v_fmac_f32 v24, v45, v52
  v_fmac_f32 v25, v45, v53
  v_lshlrev_b32 v52, 16, v109
  v_and_b32 v53, 0xffff0000, v109
  v_fmac_f32 v26, v45, v52
  v_fmac_f32 v27, v45, v53
  v_lshlrev_b32 v52, 16, v110
  v_and_b32 v53, 0xffff0000, v110
  v_fmac_f32 v28, v45, v52
  v_fmac_f32 v29, v45, v53
  v_lshlrev_b32 v52, 16, v111
  v_and_b32 v53, 0xffff0000, v111
  v_fmac_f32 v30, v45, v52
  v_fmac_f32 v31, v45, v53
  v_lshlrev_b32 v52, 16, v112
  v_and_b32 v53, 0xffff0000, v112
  v_fmac_f32 v24, v46, v52
  v_fmac_f32 v25, v46, v53
  v_lshlrev_b32 v52, 16, v113
  v_and_b32 v53, 0xffff0000, v113
  v_fmac_f32 v26, v46, v52
  v_fmac_f32 v27, v46, v53
  v_lshlrev_b32 v52, 16, v114
  v_and_b32 v53, 0xffff0000, v114
  v_fmac_f32 v28, v46, v52
  v_fmac_f32 v29, v46, v53
  v_lshlrev_b32 v52, 16, v115
  v_and_b32 v53, 0xffff0000, v115
  v_fmac_f32 v30, v46, v52
  v_fmac_f32 v31, v46, v53
  v_lshlrev_b32 v52, 16, v116
  v_and_b32 v53, 0xffff0000, v116
  v_fmac_f32 v24, v47, v52
  v_fmac_f32 v25, v47, v53
  v_lshlrev_b32 v52, 16, v117
  v_and_b32 v53, 0xffff0000, v117
  v_fmac_f32 v26, v47, v52
  v_fmac_f32 v27, v47, v53
  v_lshlrev_b32 v52, 16, v118
  v_and_b32 v53, 0xffff0000, v118
  v_fmac_f32 v28, v47, v52
  v_fmac_f32 v29, v47, v53
  v_lshlrev_b32 v52, 16, v119
  v_and_b32 v53, 0xffff0000, v119
  v_fmac_f32 v30, v47, v52
  v_fmac_f32 v31, v47, v53
  v_lshlrev_b32 v52, 16, v120
  v_and_b32 v53, 0xffff0000, v120
  v_fmac_f32 v24, v48, v52
  v_fmac_f32 v25, v48, v53
  v_lshlrev_b32 v52, 16, v121
  v_and_b32 v53, 0xffff0000, v121
  v_fmac_f32 v26, v48, v52
  v_fmac_f32 v27, v48, v53
  v_lshlrev_b32 v52, 16, v122
  v_and_b32 v53, 0xffff0000, v122
  v_fmac_f32 v28, v48, v52
  v_fmac_f32 v29, v48, v53
  v_lshlrev_b32 v52, 16, v123
  v_and_b32 v53, 0xffff0000, v123
  v_fmac_f32 v30, v48, v52
  v_fmac_f32 v31, v48, v53
  v_lshlrev_b32 v52, 16, v124
  v_and_b32 v53, 0xffff0000, v124
  v_fmac_f32 v24, v49, v52
  v_fmac_f32 v25, v49, v53
  v_lshlrev_b32 v52, 16, v125
  v_and_b32 v53, 0xffff0000, v125
  v_fmac_f32 v26, v49, v52
  v_fmac_f32 v27, v49, v53
  v_lshlrev_b32 v52, 16, v126
  v_and_b32 v53, 0xffff0000, v126
  v_fmac_f32 v28, v49, v52
  v_fmac_f32 v29, v49, v53
  v_lshlrev_b32 v52, 16, v127
  v_and_b32 v53, 0xffff0000, v127
  v_fmac_f32 v30, v49, v52
  v_fmac_f32 v31, v49, v53
  buffer_load_dwordx4 v[96:99], v60, s[56:59], s73 offen offset:0 nt
  buffer_load_dwordx4 v[100:103], v60, s[56:59], s73 offen offset:256 nt
  buffer_load_dwordx4 v[104:107], v60, s[56:59], s73 offen offset:512 nt
  buffer_load_dwordx4 v[108:111], v60, s[56:59], s73 offen offset:768 nt
  buffer_load_dwordx4 v[112:115], v61, s[56:59], s73 offen offset:0 nt
  buffer_load_dwordx4 v[116:119], v61, s[56:59], s73 offen offset:256 nt
  buffer_load_dwordx4 v[120:123], v61, s[56:59], s73 offen offset:512 nt
  buffer_load_dwordx4 v[124:127], v61, s[56:59], s73 offen offset:768 nt
  s_cmp_eq_u32 s75, 1073741824
  s_cbranch_scc1 L_bdone
  s_mov_b64 exec, 1
  ds_add_rtn_u32 v42, v57, v56
  s_mov_b64 exec, -1
  s_waitcnt vmcnt(40)
  v_dot2_f32_bf16 v34, v128, v8, 0
  v_dot2_f32_bf16 v35, v132, v8, 0
  v_dot2_f32_bf16 v36, v136, v8, 0
  v_dot2_f32_bf16 v37, v140, v8, 0
  v_dot2_f32_bf16 v38, v144, v8, 0
  v_dot2_f32_bf16 v39, v148, v8, 0
  v_dot2_f32_bf16 v40, v152, v8, 0
  v_dot2_f32_bf16 v41, v156, v8, 0
  v_dot2_f32_bf16 v34, v129, v9, v34
  v_dot2_f32_bf16 v35, v133, v9, v35
  v_dot2_f32_bf16 v36, v137, v9, v36
  v_dot2_f32_bf16 v37, v141, v9, v37
  v_dot2_f32_bf16 v38, v145, v9, v38
  v_dot2_f32_bf16 v39, v149, v9, v39
  v_dot2_f32_bf16 v40, v153, v9, v40
  v_dot2_f32_bf16 v41, v157, v9, v41
  v_dot2_f32_bf16 v34, v130, v10, v34
  v_dot2_f32_bf16 v35, v134, v10, v35
  v_dot2_f32_bf16 v36, v138, v10, v36
  v_dot2_f32_bf16 v37, v142, v10, v37
  v_dot2_f32_bf16 v38, v146, v10, v38
  v_dot2_f32_bf16 v39, v150, v10, v39
  v_dot2_f32_bf16 v40, v154, v10, v40
  v_dot2_f32_bf16 v41, v158, v10, v41
  v_dot2_f32_bf16 v34, v131, v11, v34
  v_dot2_f32_bf16 v35, v135, v11, v35
  v_dot2_f32_bf16 v36, v139, v11, v36
  v_dot2_f32_bf16 v37, v143, v11, v37
  v_dot2_f32_bf16 v38, v147, v11, v38
  v_dot2_f32_bf16 v39, v151, v11, v39
  v_dot2_f32_bf16 v40, v155, v11, v40
  v_dot2_f32_bf16 v41, v159, v11, v41
  s_waitcnt lgkmcnt(0)
  v_readfirstlane_b32 s66, v42
  s_lshl_b32 s67, s66, 13
  s_cmp_lt_u32 s66, s70
  s_cselect_b32 s73, s67, 1073741824
  s_mov_b32 s75, s73
  buffer_load_dwordx4 v[128:131], v60, s[52:55], s73 offen offset:0 nt
  buffer_load_dwordx4 v[132:135], v60, s[52:55], s73 offen offset:256 nt
  buffer_load_dwordx4 v[136:139], v60, s[52:55], s73 offen offset:512 nt
  buffer_load_dwordx4 v[140:143], v60, s[52:55], s73 offen offset:768 nt
  buffer_load_dwordx4 v[144:147], v61, s[52:55], s73 offen offset:0 nt
  buffer_load_dwordx4 v[148:151], v61, s[52:55], s73 offen offset:256 nt
  buffer_load_dwordx4 v[152:155], v61, s[52:55], s73 offen offset:512 nt
  buffer_load_dwordx4 v[156:159], v61, s[52:55], s73 offen offset:768 nt
  v_add_f32_dpp v34, v34, v34 row_ror:8 row_mask:0xf bank_mask:0xf
  v_add_f32_dpp v35, v35, v35 row_ror:8 row_mask:0xf bank_mask:0xf
  v_add_f32_dpp v36, v36, v36 row_ror:8 row_mask:0xf bank_mask:0xf
  v_add_f32_dpp v37, v37, v37 row_ror:8 row_mask:0xf bank_mask:0xf
  v_add_f32_dpp v38, v38, v38 row_ror:8 row_mask:0xf bank_mask:0xf
  v_add_f32_dpp v39, v39, v39 row_ror:8 row_mask:0xf bank_mask:0xf
  v_add_f32_dpp v40, v40, v40 row_ror:8 row_mask:0xf bank_mask:0xf
  v_add_f32_dpp v41, v41, v41 row_ror:8 row_mask:0xf bank_mask:0xf
  v_add_f32_dpp v34, v34, v34 row_ror:4 row_mask:0xf bank_mask:0xf
  v_add_f32_dpp v35, v35, v35 row_ror:4 row_mask:0xf bank_mask:0xf
  v_add_f32_dpp v36, v36, v36 row_ror:4 row_mask:0xf bank_mask:0xf
  v_add_f32_dpp v37, v37, v37 row_ror:4 row_mask:0xf bank_mask:0xf
  v_add_f32_dpp v38, v38, v38 row_ror:4 row_mask:0xf bank_mask:0xf
  v_add_f32_dpp v39, v39, v39 row_ror:4 row_mask:0xf bank_mask:0xf
  v_add_f32_dpp v40, v40, v40 row_ror:4 row_mask:0xf bank_mask:0xf
  v_add_f32_dpp v41, v41, v41 row_ror:4 row_mask:0xf bank_mask:0xf
  v_add_f32_dpp v34, v34, v34 row_ror:2 row_mask:0xf bank_mask:0xf
  v_add_f32_dpp v35, v35, v35 row_ror:2 row_mask:0xf bank_mask:0xf
  v_add_f32_dpp v36, v36, v36 row_ror:2 row_mask:0xf bank_mask:0xf
  v_add_f32_dpp v37, v37, v37 row_ror:2 row_mask:0xf bank_mask:0xf
  v_add_f32_dpp v38, v38, v38 row_ror:2 row_mask:0xf bank_mask:0xf
  v_add_f32_dpp v39, v39, v39 row_ror:2 row_mask:0xf bank_mask:0xf
  v_add_f32_dpp v40, v40, v40 row_ror:2 row_mask:0xf bank_mask:0xf
  v_add_f32_dpp v41, v41, v41 row_ror:2 row_mask:0xf bank_mask:0xf
  v_add_f32_dpp v34, v34, v34 row_ror:1 row_mask:0xf bank_mask:0xf
  v_add_f32_dpp v35, v35, v35 row_ror:1 row_mask:0xf bank_mask:0xf
  v_add_f32_dpp v36, v36, v36 row_ror:1 row_mask:0xf bank_mask:0xf
  v_add_f32_dpp v37, v37, v37 row_ror:1 row_mask:0xf bank_mask:0xf
  v_add_f32_dpp v38, v38, v38 row_ror:1 row_mask:0xf bank_mask:0xf
  v_add_f32_dpp v39, v39, v39 row_ror:1 row_mask:0xf bank_mask:0xf
  v_add_f32_dpp v40, v40, v40 row_ror:1 row_mask:0xf bank_mask:0xf
  v_add_f32_dpp v41, v41, v41 row_ror:1 row_mask:0xf bank_mask:0xf
  v_cvt_pk_bf16_f32 v50, v34, v35
  v_lshlrev_b32 v42, 16, v50
  v_and_b32 v43, 0xffff0000, v50
  v_mul_f32 v42, s81, v42
  v_mul_f32 v43, s81, v43
  v_cvt_pk_bf16_f32 v50, v42, v43
  v_lshlrev_b32 v42, 16, v50
  v_and_b32 v43, 0xffff0000, v50
  v_cvt_pk_bf16_f32 v50, v36, v37
  v_lshlrev_b32 v44, 16, v50
  v_and_b32 v45, 0xffff0000, v50
  v_mul_f32 v44, s81, v44
  v_mul_f32 v45, s81, v45
  v_cvt_pk_bf16_f32 v50, v44, v45
  v_lshlrev_b32 v44, 16, v50
  v_and_b32 v45, 0xffff0000, v50
  v_cvt_pk_bf16_f32 v50, v38, v39
  v_lshlrev_b32 v46, 16, v50
  v_and_b32 v47, 0xffff0000, v50
  v_mul_f32 v46, s81, v46
  v_mul_f32 v47, s81, v47
  v_cvt_pk_bf16_f32 v50, v46, v47
  v_lshlrev_b32 v46, 16, v50
  v_and_b32 v47, 0xffff0000, v50
  v_cvt_pk_bf16_f32 v50, v40, v41
  v_lshlrev_b32 v48, 16, v50
  v_and_b32 v49, 0xffff0000, v50
  v_mul_f32 v48, s81, v48
  v_mul_f32 v49, s81, v49
  v_cvt_pk_bf16_f32 v50, v48, v49
  v_lshlrev_b32 v48, 16, v50
  v_and_b32 v49, 0xffff0000, v50
  v_max3_f32 v50, v42, v43, v44
  v_max3_f32 v51, v45, v46, v47
  v_max3_f32 v52, v48, v49, v32
  v_max3_f32 v50, v50, v51, v52
  v_sub_f32 v51, v32, v50
  v_mul_f32 v51, s80, v51
  v_exp_f32 v51, v51
  v_mov_b32 v32, v50
  v_sub_f32 v42, v42, v50
  v_sub_f32 v43, v43, v50
  v_sub_f32 v44, v44, v50
  v_sub_f32 v45, v45, v50
  v_sub_f32 v46, v46, v50
  v_sub_f32 v47, v47, v50
  v_sub_f32 v48, v48, v50
  v_sub_f32 v49, v49, v50
  v_mul_f32 v42, s80, v42
  v_mul_f32 v43, s80, v43
  v_mul_f32 v44, s80, v44
  v_mul_f32 v45, s80, v45
  v_mul_f32 v46, s80, v46
  v_mul_f32 v47, s80, v47
  v_mul_f32 v48, s80, v48
  v_mul_f32 v49, s80, v49
  v_exp_f32 v42, v42
  v_exp_f32 v43, v43
  v_exp_f32 v44, v44
  v_exp_f32 v45, v45
  v_exp_f32 v46, v46
  v_exp_f32 v47, v47
  v_exp_f32 v48, v48
  v_exp_f32 v49, v49
  v_mul_f32 v33, v33, v51
  v_mul_f32 v24, v24, v51
  v_mul_f32 v25, v25, v51
  v_mul_f32 v26, v26, v51
  v_mul_f32 v27, v27, v51
  v_mul_f32 v28, v28, v51
  v_mul_f32 v29, v29, v51
  v_mul_f32 v30, v30, v51
  v_mul_f32 v31, v31, v51
  v_add_f32 v52, v42, v43
  v_add_f32 v53, v44, v45
  v_add_f32 v54, v46, v47
  v_add_f32 v55, v48, v49
  v_add_f32 v52, v52, v53
  v_add_f32 v54, v54, v55
  v_add_f32 v52, v52, v54
  v_add_f32 v33, v33, v52
  s_waitcnt vmcnt(40)
  v_lshlrev_b32 v52, 16, v160
  v_and_b32 v53, 0xffff0000, v160
  v_fmac_f32 v24, v42, v52
  v_fmac_f32 v25, v42, v53
  v_lshlrev_b32 v52, 16, v161
  v_and_b32 v53, 0xffff0000, v161
  v_fmac_f32 v26, v42, v52
  v_fmac_f32 v27, v42, v53
  v_lshlrev_b32 v52, 16, v162
  v_and_b32 v53, 0xffff0000, v162
  v_fmac_f32 v28, v42, v52
  v_fmac_f32 v29, v42, v53
  v_lshlrev_b32 v52, 16, v163
  v_and_b32 v53, 0xffff0000, v163
  v_fmac_f32 v30, v42, v52
  v_fmac_f32 v31, v42, v53
  v_lshlrev_b32 v52, 16, v164
  v_and_b32 v53, 0xffff0000, v164
  v_fmac_f32 v24, v43, v52
  v_fmac_f32 v25, v43, v53
  v_lshlrev_b32 v52, 16, v165
  v_and_b32 v53, 0xffff0000, v165
  v_fmac_f32 v26, v43, v52
  v_fmac_f32 v27, v43, v53
  v_lshlrev_b32 v52, 16, v166
  v_and_b32 v53, 0xffff0000, v166
  v_fmac_f32 v28, v43, v52
  v_fmac_f32 v29, v43, v53
  v_lshlrev_b32 v52, 16, v167
  v_and_b32 v53, 0xffff0000, v167
  v_fmac_f32 v30, v43, v52
  v_fmac_f32 v31, v43, v53
  v_lshlrev_b32 v52, 16, v168
  v_and_b32 v53, 0xffff0000, v168
  v_fmac_f32 v24, v44, v52
  v_fmac_f32 v25, v44, v53
  v_lshlrev_b32 v52, 16, v169
  v_and_b32 v53, 0xffff0000, v169
  v_fmac_f32 v26, v44, v52
  v_fmac_f32 v27, v44, v53
  v_lshlrev_b32 v52, 16, v170
  v_and_b32 v53, 0xffff0000, v170
  v_fmac_f32 v28, v44, v52
  v_fmac_f32 v29, v44, v53
  v_lshlrev_b32 v52, 16, v171
  v_and_b32 v53, 0xffff0000, v171
  v_fmac_f32 v30, v44, v52
  v_fmac_f32 v31, v44, v53
  v_lshlrev_b32 v52, 16, v172
  v_and_b32 v53, 0xffff0000, v172
  v_fmac_f32 v24, v45, v52
  v_fmac_f32 v25, v45, v53
  v_lshlrev_b32 v52, 16, v173
  v_and_b32 v53, 0xffff0000, v173
  v_fmac_f32 v26, v45, v52
  v_fmac_f32 v27, v45, v53
  v_lshlrev_b32 v52, 16, v174
  v_and_b32 v53, 0xffff0000, v174
  v_fmac_f32 v28, v45, v52
  v_fmac_f32 v29, v45, v53
  v_lshlrev_b32 v52, 16, v175
  v_and_b32 v53, 0xffff0000, v175
  v_fmac_f32 v30, v45, v52
  v_fmac_f32 v31, v45, v53
  v_lshlrev_b32 v52, 16, v176
  v_and_b32 v53, 0xffff0000, v176
  v_fmac_f32 v24, v46, v52
  v_fmac_f32 v25, v46, v53
  v_lshlrev_b32 v52, 16, v177
  v_and_b32 v53, 0xffff0000, v177
  v_fmac_f32 v26, v46, v52
  v_fmac_f32 v27, v46, v53
  v_lshlrev_b32 v52, 16, v178
  v_and_b32 v53, 0xffff0000, v178
  v_fmac_f32 v28, v46, v52
  v_fmac_f32 v29, v46, v53
  v_lshlrev_b32 v52, 16, v179
  v_and_b32 v53, 0xffff0000, v179
  v_fmac_f32 v30, v46, v52
  v_fmac_f32 v31, v46, v53
  v_lshlrev_b32 v52, 16, v180
  v_and_b32 v53, 0xffff0000, v180
  v_fmac_f32 v24, v47, v52
  v_fmac_f32 v25, v47, v53
  v_lshlrev_b32 v52, 16, v181
  v_and_b32 v53, 0xffff0000, v181
  v_fmac_f32 v26, v47, v52
  v_fmac_f32 v27, v47, v53
  v_lshlrev_b32 v52, 16, v182
  v_and_b32 v53, 0xffff0000, v182
  v_fmac_f32 v28, v47, v52
  v_fmac_f32 v29, v47, v53
  v_lshlrev_b32 v52, 16, v183
  v_and_b32 v53, 0xffff0000, v183
  v_fmac_f32 v30, v47, v52
  v_fmac_f32 v31, v47, v53
  v_lshlrev_b32 v52, 16, v184
  v_and_b32 v53, 0xffff0000, v184
  v_fmac_f32 v24, v48, v52
  v_fmac_f32 v25, v48, v53
  v_lshlrev_b32 v52, 16, v185
  v_and_b32 v53, 0xffff0000, v185
  v_fmac_f32 v26, v48, v52
  v_fmac_f32 v27, v48, v53
  v_lshlrev_b32 v52, 16, v186
  v_and_b32 v53, 0xffff0000, v186
  v_fmac_f32 v28, v48, v52
  v_fmac_f32 v29, v48, v53
  v_lshlrev_b32 v52, 16, v187
  v_and_b32 v53, 0xffff0000, v187
  v_fmac_f32 v30, v48, v52
  v_fmac_f32 v31, v48, v53
  v_lshlrev_b32 v52, 16, v188
  v_and_b32 v53, 0xffff0000, v188
  v_fmac_f32 v24, v49, v52
  v_fmac_f32 v25, v49, v53
  v_lshlrev_b32 v52, 16, v189
  v_and_b32 v53, 0xffff0000, v189
  v_fmac_f32 v26, v49, v52
  v_fmac_f32 v27, v49, v53
  v_lshlrev_b32 v52, 16, v190
  v_and_b32 v53, 0xffff0000, v190
  v_fmac_f32 v28, v49, v52
  v_fmac_f32 v29, v49, v53
  v_lshlrev_b32 v52, 16, v191
  v_and_b32 v53, 0xffff0000, v191
  v_fmac_f32 v30, v49, v52
  v_fmac_f32 v31, v49, v53
  buffer_load_dwordx4 v[160:163], v60, s[56:59], s73 offen offset:0 nt
  buffer_load_dwordx4 v[164:167], v60, s[56:59], s73 offen offset:256 nt
  buffer_load_dwordx4 v[168:171], v60, s[56:59], s73 offen offset:512 nt
  buffer_load_dwordx4 v[172:175], v60, s[56:59], s73 offen offset:768 nt
  buffer_load_dwordx4 v[176:179], v61, s[56:59], s73 offen offset:0 nt
  buffer_load_dwordx4 v[180:183], v61, s[56:59], s73 offen offset:256 nt
  buffer_load_dwordx4 v[184:187], v61, s[56:59], s73 offen offset:512 nt
  buffer_load_dwordx4 v[188:191], v61, s[56:59], s73 offen offset:768 nt
  s_cmp_eq_u32 s74, 1073741824
  s_cbranch_scc1 L_bdone
  s_mov_b64 exec, 1
  ds_add_rtn_u32 v42, v57, v56
  s_mov_b64 exec, -1
  s_waitcnt vmcnt(40)
  v_dot2_f32_bf16 v34, v64, v8, 0
  v_dot2_f32_bf16 v35, v68, v8, 0
  v_dot2_f32_bf16 v36, v72, v8, 0
  v_dot2_f32_bf16 v37, v76, v8, 0
  v_dot2_f32_bf16 v38, v80, v8, 0
  v_dot2_f32_bf16 v39, v84, v8, 0
  v_dot2_f32_bf16 v40, v88, v8, 0
  v_dot2_f32_bf16 v41, v92, v8, 0
  v_dot2_f32_bf16 v34, v65, v9, v34
  v_dot2_f32_bf16 v35, v69, v9, v35
  v_dot2_f32_bf16 v36, v73, v9, v36
  v_dot2_f32_bf16 v37, v77, v9, v37
  v_dot2_f32_bf16 v38, v81, v9, v38
  v_dot2_f32_bf16 v39, v85, v9, v39
  v_dot2_f32_bf16 v40, v89, v9, v40
  v_dot2_f32_bf16 v41, v93, v9, v41
  v_dot2_f32_bf16 v34, v66, v10, v34
  v_dot2_f32_bf16 v35, v70, v10, v35
  v_dot2_f32_bf16 v36, v74, v10, v36
  v_dot2_f32_bf16 v37, v78, v10, v37
  v_dot2_f32_bf16 v38, v82, v10, v38
  v_dot2_f32_bf16 v39, v86, v10, v39
  v_dot2_f32_bf16 v40, v90, v10, v40
  v_dot2_f32_bf16 v41, v94, v10, v41
  v_dot2_f32_bf16 v34, v67, v11, v34
  v_dot2_f32_bf16 v35, v71, v11, v35
  v_dot2_f32_bf16 v36, v75, v11, v36
  v_dot2_f32_bf16 v37, v79, v11, v37
  v_dot2_f32_bf16 v38, v83, v11, v38
  v_dot2_f32_bf16 v39, v87, v11, v39
  v_dot2_f32_bf16 v40, v91, v11, v40
  v_dot2_f32_bf16 v41, v95, v11, v41
  s_waitcnt lgkmcnt(0)
  v_readfirstlane_b32 s66, v42
  s_lshl_b32 s67, s66, 13
  s_cmp_lt_u32 s66, s70
  s_cselect_b32 s73, s67, 1073741824
  s_mov_b32 s74, s73
  buffer_load_dwordx4 v[64:67], v60, s[52:55], s73 offen offset:0 nt
  buffer_load_dwordx4 v[68:71], v60, s[52:55], s73 offen offset:256 nt
  buffer_load_dwordx4 v[72:75], v60, s[52:55], s73 offen offset:512 nt
  buffer_load_dwordx4 v[76:79], v60, s[52:55], s73 offen offset:768 nt
  buffer_load_dwordx4 v[80:83], v61, s[52:55], s73 offen offset:0 nt
  buffer_load_dwordx4 v[84:87], v61, s[52:55], s73 offen offset:256 nt
  buffer_load_dwordx4 v[88:91], v61, s[52:55], s73 offen offset:512 nt
  buffer_load_dwordx4 v[92:95], v61, s[52:55], s73 offen offset:768 nt
  v_add_f32_dpp v34, v34, v34 row_ror:8 row_mask:0xf bank_mask:0xf
  v_add_f32_dpp v35, v35, v35 row_ror:8 row_mask:0xf bank_mask:0xf
  v_add_f32_dpp v36, v36, v36 row_ror:8 row_mask:0xf bank_mask:0xf
  v_add_f32_dpp v37, v37, v37 row_ror:8 row_mask:0xf bank_mask:0xf
  v_add_f32_dpp v38, v38, v38 row_ror:8 row_mask:0xf bank_mask:0xf
  v_add_f32_dpp v39, v39, v39 row_ror:8 row_mask:0xf bank_mask:0xf
  v_add_f32_dpp v40, v40, v40 row_ror:8 row_mask:0xf bank_mask:0xf
  v_add_f32_dpp v41, v41, v41 row_ror:8 row_mask:0xf bank_mask:0xf
  v_add_f32_dpp v34, v34, v34 row_ror:4 row_mask:0xf bank_mask:0xf
  v_add_f32_dpp v35, v35, v35 row_ror:4 row_mask:0xf bank_mask:0xf
  v_add_f32_dpp v36, v36, v36 row_ror:4 row_mask:0xf bank_mask:0xf
  v_add_f32_dpp v37, v37, v37 row_ror:4 row_mask:0xf bank_mask:0xf
  v_add_f32_dpp v38, v38, v38 row_ror:4 row_mask:0xf bank_mask:0xf
  v_add_f32_dpp v39, v39, v39 row_ror:4 row_mask:0xf bank_mask:0xf
  v_add_f32_dpp v40, v40, v40 row_ror:4 row_mask:0xf bank_mask:0xf
  v_add_f32_dpp v41, v41, v41 row_ror:4 row_mask:0xf bank_mask:0xf
  v_add_f32_dpp v34, v34, v34 row_ror:2 row_mask:0xf bank_mask:0xf
  v_add_f32_dpp v35, v35, v35 row_ror:2 row_mask:0xf bank_mask:0xf
  v_add_f32_dpp v36, v36, v36 row_ror:2 row_mask:0xf bank_mask:0xf
  v_add_f32_dpp v37, v37, v37 row_ror:2 row_mask:0xf bank_mask:0xf
  v_add_f32_dpp v38, v38, v38 row_ror:2 row_mask:0xf bank_mask:0xf
  v_add_f32_dpp v39, v39, v39 row_ror:2 row_mask:0xf bank_mask:0xf
  v_add_f32_dpp v40, v40, v40 row_ror:2 row_mask:0xf bank_mask:0xf
  v_add_f32_dpp v41, v41, v41 row_ror:2 row_mask:0xf bank_mask:0xf
  v_add_f32_dpp v34, v34, v34 row_ror:1 row_mask:0xf bank_mask:0xf
  v_add_f32_dpp v35, v35, v35 row_ror:1 row_mask:0xf bank_mask:0xf
  v_add_f32_dpp v36, v36, v36 row_ror:1 row_mask:0xf bank_mask:0xf
  v_add_f32_dpp v37, v37, v37 row_ror:1 row_mask:0xf bank_mask:0xf
  v_add_f32_dpp v38, v38, v38 row_ror:1 row_mask:0xf bank_mask:0xf
  v_add_f32_dpp v39, v39, v39 row_ror:1 row_mask:0xf bank_mask:0xf
  v_add_f32_dpp v40, v40, v40 row_ror:1 row_mask:0xf bank_mask:0xf
  v_add_f32_dpp v41, v41, v41 row_ror:1 row_mask:0xf bank_mask:0xf
  v_cvt_pk_bf16_f32 v50, v34, v35
  v_lshlrev_b32 v42, 16, v50
  v_and_b32 v43, 0xffff0000, v50
  v_mul_f32 v42, s81, v42
  v_mul_f32 v43, s81, v43
  v_cvt_pk_bf16_f32 v50, v42, v43
  v_lshlrev_b32 v42, 16, v50
  v_and_b32 v43, 0xffff0000, v50
  v_cvt_pk_bf16_f32 v50, v36, v37
  v_lshlrev_b32 v44, 16, v50
  v_and_b32 v45, 0xffff0000, v50
  v_mul_f32 v44, s81, v44
  v_mul_f32 v45, s81, v45
  v_cvt_pk_bf16_f32 v50, v44, v45
  v_lshlrev_b32 v44, 16, v50
  v_and_b32 v45, 0xffff0000, v50
  v_cvt_pk_bf16_f32 v50, v38, v39
  v_lshlrev_b32 v46, 16, v50
  v_and_b32 v47, 0xffff0000, v50
  v_mul_f32 v46, s81, v46
  v_mul_f32 v47, s81, v47
  v_cvt_pk_bf16_f32 v50, v46, v47
  v_lshlrev_b32 v46, 16, v50
  v_and_b32 v47, 0xffff0000, v50
  v_cvt_pk_bf16_f32 v50, v40, v41
  v_lshlrev_b32 v48, 16, v50
  v_and_b32 v49, 0xffff0000, v50
  v_mul_f32 v48, s81, v48
  v_mul_f32 v49, s81, v49
  v_cvt_pk_bf16_f32 v50, v48, v49
  v_lshlrev_b32 v48, 16, v50
  v_and_b32 v49, 0xffff0000, v50
  v_max3_f32 v50, v42, v43, v44
  v_max3_f32 v51, v45, v46, v47
  v_max3_f32 v52, v48, v49, v32
  v_max3_f32 v50, v50, v51, v52
  v_sub_f32 v51, v32, v50
  v_mul_f32 v51, s80, v51
  v_exp_f32 v51, v51
  v_mov_b32 v32, v50
  v_sub_f32 v42, v42, v50
  v_sub_f32 v43, v43, v50
  v_sub_f32 v44, v44, v50
  v_sub_f32 v45, v45, v50
  v_sub_f32 v46, v46, v50
  v_sub_f32 v47, v47, v50
  v_sub_f32 v48, v48, v50
  v_sub_f32 v49, v49, v50
  v_mul_f32 v42, s80, v42
  v_mul_f32 v43, s80, v43
  v_mul_f32 v44, s80, v44
  v_mul_f32 v45, s80, v45
  v_mul_f32 v46, s80, v46
  v_mul_f32 v47, s80, v47
  v_mul_f32 v48, s80, v48
  v_mul_f32 v49, s80, v49
  v_exp_f32 v42, v42
  v_exp_f32 v43, v43
  v_exp_f32 v44, v44
  v_exp_f32 v45, v45
  v_exp_f32 v46, v46
  v_exp_f32 v47, v47
  v_exp_f32 v48, v48
  v_exp_f32 v49, v49
  v_mul_f32 v33, v33, v51
  v_mul_f32 v24, v24, v51
  v_mul_f32 v25, v25, v51
  v_mul_f32 v26, v26, v51
  v_mul_f32 v27, v27, v51
  v_mul_f32 v28, v28, v51
  v_mul_f32 v29, v29, v51
  v_mul_f32 v30, v30, v51
  v_mul_f32 v31, v31, v51
  v_add_f32 v52, v42, v43
  v_add_f32 v53, v44, v45
  v_add_f32 v54, v46, v47
  v_add_f32 v55, v48, v49
  v_add_f32 v52, v52, v53
  v_add_f32 v54, v54, v55
  v_add_f32 v52, v52, v54
  v_add_f32 v33, v33, v52
  s_waitcnt vmcnt(24)
  v_lshlrev_b32 v52, 16, v96
  v_and_b32 v53, 0xffff0000, v96
  v_fmac_f32 v24, v42, v52
  v_fmac_f32 v25, v42, v53
  v_lshlrev_b32 v52, 16, v97
  v_and_b32 v53, 0xffff0000, v97
  v_fmac_f32 v26, v42, v52
  v_fmac_f32 v27, v42, v53
  v_lshlrev_b32 v52, 16, v98
  v_and_b32 v53, 0xffff0000, v98
  v_fmac_f32 v28, v42, v52
  v_fmac_f32 v29, v42, v53
  v_lshlrev_b32 v52, 16, v99
  v_and_b32 v53, 0xffff0000, v99
  v_fmac_f32 v30, v42, v52
  v_fmac_f32 v31, v42, v53
  v_lshlrev_b32 v52, 16, v100
  v_and_b32 v53, 0xffff0000, v100
  v_fmac_f32 v24, v43, v52
  v_fmac_f32 v25, v43, v53
  v_lshlrev_b32 v52, 16, v101
  v_and_b32 v53, 0xffff0000, v101
  v_fmac_f32 v26, v43, v52
  v_fmac_f32 v27, v43, v53
  v_lshlrev_b32 v52, 16, v102
  v_and_b32 v53, 0xffff0000, v102
  v_fmac_f32 v28, v43, v52
  v_fmac_f32 v29, v43, v53
  v_lshlrev_b32 v52, 16, v103
  v_and_b32 v53, 0xffff0000, v103
  v_fmac_f32 v30, v43, v52
  v_fmac_f32 v31, v43, v53
  v_lshlrev_b32 v52, 16, v104
  v_and_b32 v53, 0xffff0000, v104
  v_fmac_f32 v24, v44, v52
  v_fmac_f32 v25, v44, v53
  v_lshlrev_b32 v52, 16, v105
  v_and_b32 v53, 0xffff0000, v105
  v_fmac_f32 v26, v44, v52
  v_fmac_f32 v27, v44, v53
  v_lshlrev_b32 v52, 16, v106
  v_and_b32 v53, 0xffff0000, v106
  v_fmac_f32 v28, v44, v52
  v_fmac_f32 v29, v44, v53
  v_lshlrev_b32 v52, 16, v107
  v_and_b32 v53, 0xffff0000, v107
  v_fmac_f32 v30, v44, v52
  v_fmac_f32 v31, v44, v53
  v_lshlrev_b32 v52, 16, v108
  v_and_b32 v53, 0xffff0000, v108
  v_fmac_f32 v24, v45, v52
  v_fmac_f32 v25, v45, v53
  v_lshlrev_b32 v52, 16, v109
  v_and_b32 v53, 0xffff0000, v109
  v_fmac_f32 v26, v45, v52
  v_fmac_f32 v27, v45, v53
  v_lshlrev_b32 v52, 16, v110
  v_and_b32 v53, 0xffff0000, v110
  v_fmac_f32 v28, v45, v52
  v_fmac_f32 v29, v45, v53
  v_lshlrev_b32 v52, 16, v111
  v_and_b32 v53, 0xffff0000, v111
  v_fmac_f32 v30, v45, v52
  v_fmac_f32 v31, v45, v53
  v_lshlrev_b32 v52, 16, v112
  v_and_b32 v53, 0xffff0000, v112
  v_fmac_f32 v24, v46, v52
  v_fmac_f32 v25, v46, v53
  v_lshlrev_b32 v52, 16, v113
  v_and_b32 v53, 0xffff0000, v113
  v_fmac_f32 v26, v46, v52
  v_fmac_f32 v27, v46, v53
  v_lshlrev_b32 v52, 16, v114
  v_and_b32 v53, 0xffff0000, v114
  v_fmac_f32 v28, v46, v52
  v_fmac_f32 v29, v46, v53
  v_lshlrev_b32 v52, 16, v115
  v_and_b32 v53, 0xffff0000, v115
  v_fmac_f32 v30, v46, v52
  v_fmac_f32 v31, v46, v53
  v_lshlrev_b32 v52, 16, v116
  v_and_b32 v53, 0xffff0000, v116
  v_fmac_f32 v24, v47, v52
  v_fmac_f32 v25, v47, v53
  v_lshlrev_b32 v52, 16, v117
  v_and_b32 v53, 0xffff0000, v117
  v_fmac_f32 v26, v47, v52
  v_fmac_f32 v27, v47, v53
  v_lshlrev_b32 v52, 16, v118
  v_and_b32 v53, 0xffff0000, v118
  v_fmac_f32 v28, v47, v52
  v_fmac_f32 v29, v47, v53
  v_lshlrev_b32 v52, 16, v119
  v_and_b32 v53, 0xffff0000, v119
  v_fmac_f32 v30, v47, v52
  v_fmac_f32 v31, v47, v53
  v_lshlrev_b32 v52, 16, v120
  v_and_b32 v53, 0xffff0000, v120
  v_fmac_f32 v24, v48, v52
  v_fmac_f32 v25, v48, v53
  v_lshlrev_b32 v52, 16, v121
  v_and_b32 v53, 0xffff0000, v121
  v_fmac_f32 v26, v48, v52
  v_fmac_f32 v27, v48, v53
  v_lshlrev_b32 v52, 16, v122
  v_and_b32 v53, 0xffff0000, v122
  v_fmac_f32 v28, v48, v52
  v_fmac_f32 v29, v48, v53
  v_lshlrev_b32 v52, 16, v123
  v_and_b32 v53, 0xffff0000, v123
  v_fmac_f32 v30, v48, v52
  v_fmac_f32 v31, v48, v53
  v_lshlrev_b32 v52, 16, v124
  v_and_b32 v53, 0xffff0000, v124
  v_fmac_f32 v24, v49, v52
  v_fmac_f32 v25, v49, v53
  v_lshlrev_b32 v52, 16, v125
  v_and_b32 v53, 0xffff0000, v125
  v_fmac_f32 v26, v49, v52
  v_fmac_f32 v27, v49, v53
  v_lshlrev_b32 v52, 16, v126
  v_and_b32 v53, 0xffff0000, v126
  v_fmac_f32 v28, v49, v52
  v_fmac_f32 v29, v49, v53
  v_lshlrev_b32 v52, 16, v127
  v_and_b32 v53, 0xffff0000, v127
  v_fmac_f32 v30, v49, v52
  v_fmac_f32 v31, v49, v53
  buffer_load_dwordx4 v[96:99], v60, s[56:59], s73 offen offset:0 nt
  buffer_load_dwordx4 v[100:103], v60, s[56:59], s73 offen offset:256 nt
  buffer_load_dwordx4 v[104:107], v60, s[56:59], s73 offen offset:512 nt
  buffer_load_dwordx4 v[108:111], v60, s[56:59], s73 offen offset:768 nt
  buffer_load_dwordx4 v[112:115], v61, s[56:59], s73 offen offset:0 nt
  buffer_load_dwordx4 v[116:119], v61, s[56:59], s73 offen offset:256 nt
  buffer_load_dwordx4 v[120:123], v61, s[56:59], s73 offen offset:512 nt
  buffer_load_dwordx4 v[124:127], v61, s[56:59], s73 offen offset:768 nt
  s_barrier
  v_lshrrev_b32 v44, 2, v3
  v_lshl_add_u32 v44, v2, 3, v44
  v_mul_u32_u24 v44, 1056, v44
  v_and_b32 v45, 3, v1
  v_lshl_add_u32 v44, v45, 3, v44
  s_lshl_b32 s66, s48, 7
  v_add_u32 v44, s66, v44
  v_add_u32 v45, 67584, v44
  ds_read_b64_tr_b16 v[192:193], v44 offset:0
  ds_read_b64_tr_b16 v[194:195], v44 offset:4224
  ds_read_b64_tr_b16 v[196:197], v44 offset:32
  ds_read_b64_tr_b16 v[198:199], v44 offset:4256
  ds_read_b64_tr_b16 v[200:201], v44 offset:64
  ds_read_b64_tr_b16 v[202:203], v44 offset:4288
  ds_read_b64_tr_b16 v[204:205], v44 offset:96
  ds_read_b64_tr_b16 v[206:207], v44 offset:4320
  ds_read_b64_tr_b16 v[208:209], v44 offset:33792
  ds_read_b64_tr_b16 v[210:211], v44 offset:38016
  ds_read_b64_tr_b16 v[212:213], v44 offset:33824
  ds_read_b64_tr_b16 v[214:215], v44 offset:38048
  ds_read_b64_tr_b16 v[216:217], v44 offset:33856
  ds_read_b64_tr_b16 v[218:219], v44 offset:38080
  ds_read_b64_tr_b16 v[220:221], v44 offset:33888
  ds_read_b64_tr_b16 v[222:223], v44 offset:38112
  ds_read_b64_tr_b16 v[224:225], v45 offset:0
  ds_read_b64_tr_b16 v[226:227], v45 offset:4224
  ds_read_b64_tr_b16 v[228:229], v45 offset:32
  ds_read_b64_tr_b16 v[230:231], v45 offset:4256
  ds_read_b64_tr_b16 v[232:233], v45 offset:64
  ds_read_b64_tr_b16 v[234:235], v45 offset:4288
  ds_read_b64_tr_b16 v[236:237], v45 offset:96
  ds_read_b64_tr_b16 v[238:239], v45 offset:4320
  ds_read_b64_tr_b16 v[240:241], v45 offset:33792
  ds_read_b64_tr_b16 v[242:243], v45 offset:38016
  ds_read_b64_tr_b16 v[244:245], v45 offset:33824
  ds_read_b64_tr_b16 v[246:247], v45 offset:38048
  ds_read_b64_tr_b16 v[248:249], v45 offset:33856
  ds_read_b64_tr_b16 v[250:251], v45 offset:38080
  ds_read_b64_tr_b16 v[252:253], v45 offset:33888
  ds_read_b64_tr_b16 v[254:255], v45 offset:38112
  s_waitcnt lgkmcnt(0)
  s_mov_b32 s76, 1
L_bloop:
  s_cmp_eq_u32 s75, 1073741824
  s_cbranch_scc1 L_bdone
  s_mov_b64 exec, 1
  ds_add_rtn_u32 v42, v57, v56
  s_mov_b64 exec, -1
  s_waitcnt vmcnt(24)
  v_dot2_f32_bf16 v34, v128, v8, 0
  v_dot2_f32_bf16 v35, v132, v8, 0
  v_dot2_f32_bf16 v36, v136, v8, 0
  v_dot2_f32_bf16 v37, v140, v8, 0
  v_dot2_f32_bf16 v38, v144, v8, 0
  v_dot2_f32_bf16 v39, v148, v8, 0
  v_dot2_f32_bf16 v40, v152, v8, 0
  v_dot2_f32_bf16 v41, v156, v8, 0
  v_dot2_f32_bf16 v34, v129, v9, v34
  v_dot2_f32_bf16 v35, v133, v9, v35
  v_dot2_f32_bf16 v36, v137, v9, v36
  v_dot2_f32_bf16 v37, v141, v9, v37
  v_dot2_f32_bf16 v38, v145, v9, v38
  v_dot2_f32_bf16 v39, v149, v9, v39
  v_dot2_f32_bf16 v40, v153, v9, v40
  v_dot2_f32_bf16 v41, v157, v9, v41
  v_dot2_f32_bf16 v34, v130, v10, v34
  v_dot2_f32_bf16 v35, v134, v10, v35
  v_dot2_f32_bf16 v36, v138, v10, v36
  v_dot2_f32_bf16 v37, v142, v10, v37
  v_dot2_f32_bf16 v38, v146, v10, v38
  v_dot2_f32_bf16 v39, v150, v10, v39
  v_dot2_f32_bf16 v40, v154, v10, v40
  v_dot2_f32_bf16 v41, v158, v10, v41
  v_dot2_f32_bf16 v34, v131, v11, v34
  v_dot2_f32_bf16 v35, v135, v11, v35
  v_dot2_f32_bf16 v36, v139, v11, v36
  v_dot2_f32_bf16 v37, v143, v11, v37
  v_dot2_f32_bf16 v38, v147, v11, v38
  v_dot2_f32_bf16 v39, v151, v11, v39
  v_dot2_f32_bf16 v40, v155, v11, v40
  v_dot2_f32_bf16 v41, v159, v11, v41
  s_waitcnt lgkmcnt(0)
  v_readfirstlane_b32 s66, v42
  s_lshl_b32 s67, s66, 13
  s_cmp_lt_u32 s66, s70
  s_cselect_b32 s73, s67, 1073741824
  s_mov_b32 s75, s73
  buffer_load_dwordx4 v[128:131], v60, s[52:55], s73 offen offset:0 nt
  buffer_load_dwordx4 v[132:135], v60, s[52:55], s73 offen offset:256 nt
  buffer_load_dwordx4 v[136:139], v60, s[52:55], s73 offen offset:512 nt
  buffer_load_dwordx4 v[140:143], v60, s[52:55], s73 offen offset:768 nt
  buffer_load_dwordx4 v[144:147], v61, s[52:55], s73 offen offset:0 nt
  buffer_load_dwordx4 v[148:151], v61, s[52:55], s73 offen offset:256 nt
  buffer_load_dwordx4 v[152:155], v61, s[52:55], s73 offen offset:512 nt
  buffer_load_dwordx4 v[156:159], v61, s[52:55], s73 offen offset:768 nt
  v_add_f32_dpp v34, v34, v34 row_ror:8 row_mask:0xf bank_mask:0xf
  v_add_f32_dpp v35, v35, v35 row_ror:8 row_mask:0xf bank_mask:0xf
  v_add_f32_dpp v36, v36, v36 row_ror:8 row_mask:0xf bank_mask:0xf
  v_add_f32_dpp v37, v37, v37 row_ror:8 row_mask:0xf bank_mask:0xf
  v_add_f32_dpp v38, v38, v38 row_ror:8 row_mask:0xf bank_mask:0xf
  v_add_f32_dpp v39, v39, v39 row_ror:8 row_mask:0xf bank_mask:0xf
  v_add_f32_dpp v40, v40, v40 row_ror:8 row_mask:0xf bank_mask:0xf
  v_add_f32_dpp v41, v41, v41 row_ror:8 row_mask:0xf bank_mask:0xf
  v_add_f32_dpp v34, v34, v34 row_ror:4 row_mask:0xf bank_mask:0xf
  v_add_f32_dpp v35, v35, v35 row_ror:4 row_mask:0xf bank_mask:0xf
  v_add_f32_dpp v36, v36, v36 row_ror:4 row_mask:0xf bank_mask:0xf
  v_add_f32_dpp v37, v37, v37 row_ror:4 row_mask:0xf bank_mask:0xf
  v_add_f32_dpp v38, v38, v38 row_ror:4 row_mask:0xf bank_mask:0xf
  v_add_f32_dpp v39, v39, v39 row_ror:4 row_mask:0xf bank_mask:0xf
  v_add_f32_dpp v40, v40, v40 row_ror:4 row_mask:0xf bank_mask:0xf
  v_add_f32_dpp v41, v41, v41 row_ror:4 row_mask:0xf bank_mask:0xf
  v_add_f32_dpp v34, v34, v34 row_ror:2 row_mask:0xf bank_mask:0xf
  v_add_f32_dpp v35, v35, v35 row_ror:2 row_mask:0xf bank_mask:0xf
  v_add_f32_dpp v36, v36, v36 row_ror:2 row_mask:0xf bank_mask:0xf
  v_add_f32_dpp v37, v37, v37 row_ror:2 row_mask:0xf bank_mask:0xf
  v_add_f32_dpp v38, v38, v38 row_ror:2 row_mask:0xf bank_mask:0xf
  v_add_f32_dpp v39, v39, v39 row_ror:2 row_mask:0xf bank_mask:0xf
  v_add_f32_dpp v40, v40, v40 row_ror:2 row_mask:0xf bank_mask:0xf
  v_add_f32_dpp v41, v41, v41 row_ror:2 row_mask:0xf bank_mask:0xf
  v_add_f32_dpp v34, v34, v34 row_ror:1 row_mask:0xf bank_mask:0xf
  v_add_f32_dpp v35, v35, v35 row_ror:1 row_mask:0xf bank_mask:0xf
  v_add_f32_dpp v36, v36, v36 row_ror:1 row_mask:0xf bank_mask:0xf
  v_add_f32_dpp v37, v37, v37 row_ror:1 row_mask:0xf bank_mask:0xf
  v_add_f32_dpp v38, v38, v38 row_ror:1 row_mask:0xf bank_mask:0xf
  v_add_f32_dpp v39, v39, v39 row_ror:1 row_mask:0xf bank_mask:0xf
  v_add_f32_dpp v40, v40, v40 row_ror:1 row_mask:0xf bank_mask:0xf
  v_add_f32_dpp v41, v41, v41 row_ror:1 row_mask:0xf bank_mask:0xf
  v_cvt_pk_bf16_f32 v50, v34, v35
  v_lshlrev_b32 v42, 16, v50
  v_and_b32 v43, 0xffff0000, v50
  v_mul_f32 v42, s81, v42
  v_mul_f32 v43, s81, v43
  v_cvt_pk_bf16_f32 v50, v42, v43
  v_lshlrev_b32 v42, 16, v50
  v_and_b32 v43, 0xffff0000, v50
  v_cvt_pk_bf16_f32 v50, v36, v37
  v_lshlrev_b32 v44, 16, v50
  v_and_b32 v45, 0xffff0000, v50
  v_mul_f32 v44, s81, v44
  v_mul_f32 v45, s81, v45
  v_cvt_pk_bf16_f32 v50, v44, v45
  v_lshlrev_b32 v44, 16, v50
  v_and_b32 v45, 0xffff0000, v50
  v_cvt_pk_bf16_f32 v50, v38, v39
  v_lshlrev_b32 v46, 16, v50
  v_and_b32 v47, 0xffff0000, v50
  v_mul_f32 v46, s81, v46
  v_mul_f32 v47, s81, v47
  v_cvt_pk_bf16_f32 v50, v46, v47
  v_lshlrev_b32 v46, 16, v50
  v_and_b32 v47, 0xffff0000, v50
  v_cvt_pk_bf16_f32 v50, v40, v41
  v_lshlrev_b32 v48, 16, v50
  v_and_b32 v49, 0xffff0000, v50
  v_mul_f32 v48, s81, v48
  v_mul_f32 v49, s81, v49
  v_cvt_pk_bf16_f32 v50, v48, v49
  v_lshlrev_b32 v48, 16, v50
  v_and_b32 v49, 0xffff0000, v50
  v_max3_f32 v50, v42, v43, v44
  v_max3_f32 v51, v45, v46, v47
  v_max3_f32 v52, v48, v49, v32
  v_max3_f32 v50, v50, v51, v52
  v_sub_f32 v51, v32, v50
  v_mul_f32 v51, s80, v51
  v_exp_f32 v51, v51
  v_mov_b32 v32, v50
  v_sub_f32 v42, v42, v50
  v_sub_f32 v43, v43, v50
  v_sub_f32 v44, v44, v50
  v_sub_f32 v45, v45, v50
  v_sub_f32 v46, v46, v50
  v_sub_f32 v47, v47, v50
  v_sub_f32 v48, v48, v50
  v_sub_f32 v49, v49, v50
  v_mul_f32 v42, s80, v42
  v_mul_f32 v43, s80, v43
  v_mul_f32 v44, s80, v44
  v_mul_f32 v45, s80, v45
  v_mul_f32 v46, s80, v46
  v_mul_f32 v47, s80, v47
  v_mul_f32 v48, s80, v48
  v_mul_f32 v49, s80, v49
  v_exp_f32 v42, v42
  v_exp_f32 v43, v43
  v_exp_f32 v44, v44
  v_exp_f32 v45, v45
  v_exp_f32 v46, v46
  v_exp_f32 v47, v47
  v_exp_f32 v48, v48
  v_exp_f32 v49, v49
  v_mul_f32 v33, v33, v51
  v_mul_f32 v24, v24, v51
  v_mul_f32 v25, v25, v51
  v_mul_f32 v26, v26, v51
  v_mul_f32 v27, v27, v51
  v_mul_f32 v28, v28, v51
  v_mul_f32 v29, v29, v51
  v_mul_f32 v30, v30, v51
  v_mul_f32 v31, v31, v51
  v_add_f32 v52, v42, v43
  v_add_f32 v53, v44, v45
  v_add_f32 v54, v46, v47
  v_add_f32 v55, v48, v49
  v_add_f32 v52, v52, v53
  v_add_f32 v54, v54, v55
  v_add_f32 v52, v52, v54
  v_add_f32 v33, v33, v52
  s_waitcnt vmcnt(24)
  v_lshlrev_b32 v52, 16, v160
  v_and_b32 v53, 0xffff0000, v160
  v_fmac_f32 v24, v42, v52
  v_fmac_f32 v25, v42, v53
  v_lshlrev_b32 v52, 16, v161
  v_and_b32 v53, 0xffff0000, v161
  v_fmac_f32 v26, v42, v52
  v_fmac_f32 v27, v42, v53
  v_lshlrev_b32 v52, 16, v162
  v_and_b32 v53, 0xffff0000, v162
  v_fmac_f32 v28, v42, v52
  v_fmac_f32 v29, v42, v53
  v_lshlrev_b32 v52, 16, v163
  v_and_b32 v53, 0xffff0000, v163
  v_fmac_f32 v30, v42, v52
  v_fmac_f32 v31, v42, v53
  v_lshlrev_b32 v52, 16, v164
  v_and_b32 v53, 0xffff0000, v164
  v_fmac_f32 v24, v43, v52
  v_fmac_f32 v25, v43, v53
  v_lshlrev_b32 v52, 16, v165
  v_and_b32 v53, 0xffff0000, v165
  v_fmac_f32 v26, v43, v52
  v_fmac_f32 v27, v43, v53
  v_lshlrev_b32 v52, 16, v166
  v_and_b32 v53, 0xffff0000, v166
  v_fmac_f32 v28, v43, v52
  v_fmac_f32 v29, v43, v53
  v_lshlrev_b32 v52, 16, v167
  v_and_b32 v53, 0xffff0000, v167
  v_fmac_f32 v30, v43, v52
  v_fmac_f32 v31, v43, v53
  v_lshlrev_b32 v52, 16, v168
  v_and_b32 v53, 0xffff0000, v168
  v_fmac_f32 v24, v44, v52
  v_fmac_f32 v25, v44, v53
  v_lshlrev_b32 v52, 16, v169
  v_and_b32 v53, 0xffff0000, v169
  v_fmac_f32 v26, v44, v52
  v_fmac_f32 v27, v44, v53
  v_lshlrev_b32 v52, 16, v170
  v_and_b32 v53, 0xffff0000, v170
  v_fmac_f32 v28, v44, v52
  v_fmac_f32 v29, v44, v53
  v_lshlrev_b32 v52, 16, v171
  v_and_b32 v53, 0xffff0000, v171
  v_fmac_f32 v30, v44, v52
  v_fmac_f32 v31, v44, v53
  v_lshlrev_b32 v52, 16, v172
  v_and_b32 v53, 0xffff0000, v172
  v_fmac_f32 v24, v45, v52
  v_fmac_f32 v25, v45, v53
  v_lshlrev_b32 v52, 16, v173
  v_and_b32 v53, 0xffff0000, v173
  v_fmac_f32 v26, v45, v52
  v_fmac_f32 v27, v45, v53
  v_lshlrev_b32 v52, 16, v174
  v_and_b32 v53, 0xffff0000, v174
  v_fmac_f32 v28, v45, v52
  v_fmac_f32 v29, v45, v53
  v_lshlrev_b32 v52, 16, v175
  v_and_b32 v53, 0xffff0000, v175
  v_fmac_f32 v30, v45, v52
  v_fmac_f32 v31, v45, v53
  v_lshlrev_b32 v52, 16, v176
  v_and_b32 v53, 0xffff0000, v176
  v_fmac_f32 v24, v46, v52
  v_fmac_f32 v25, v46, v53
  v_lshlrev_b32 v52, 16, v177
  v_and_b32 v53, 0xffff0000, v177
  v_fmac_f32 v26, v46, v52
  v_fmac_f32 v27, v46, v53
  v_lshlrev_b32 v52, 16, v178
  v_and_b32 v53, 0xffff0000, v178
  v_fmac_f32 v28, v46, v52
  v_fmac_f32 v29, v46, v53
  v_lshlrev_b32 v52, 16, v179
  v_and_b32 v53, 0xffff0000, v179
  v_fmac_f32 v30, v46, v52
  v_fmac_f32 v31, v46, v53
  v_lshlrev_b32 v52, 16, v180
  v_and_b32 v53, 0xffff0000, v180
  v_fmac_f32 v24, v47, v52
  v_fmac_f32 v25, v47, v53
  v_lshlrev_b32 v52, 16, v181
  v_and_b32 v53, 0xffff0000, v181
  v_fmac_f32 v26, v47, v52
  v_fmac_f32 v27, v47, v53
  v_lshlrev_b32 v52, 16, v182
  v_and_b32 v53, 0xffff0000, v182
  v_fmac_f32 v28, v47, v52
  v_fmac_f32 v29, v47, v53
  v_lshlrev_b32 v52, 16, v183
  v_and_b32 v53, 0xffff0000, v183
  v_fmac_f32 v30, v47, v52
  v_fmac_f32 v31, v47, v53
  v_lshlrev_b32 v52, 16, v184
  v_and_b32 v53, 0xffff0000, v184
  v_fmac_f32 v24, v48, v52
  v_fmac_f32 v25, v48, v53
  v_lshlrev_b32 v52, 16, v185
  v_and_b32 v53, 0xffff0000, v185
  v_fmac_f32 v26, v48, v52
  v_fmac_f32 v27, v48, v53
  v_lshlrev_b32 v52, 16, v186
  v_and_b32 v53, 0xffff0000, v186
  v_fmac_f32 v28, v48, v52
  v_fmac_f32 v29, v48, v53
  v_lshlrev_b32 v52, 16, v187
  v_and_b32 v53, 0xffff0000, v187
  v_fmac_f32 v30, v48, v52
  v_fmac_f32 v31, v48, v53
  v_lshlrev_b32 v52, 16, v188
  v_and_b32 v53, 0xffff0000, v188
  v_fmac_f32 v24, v49, v52
  v_fmac_f32 v25, v49, v53
  v_lshlrev_b32 v52, 16, v189
  v_and_b32 v53, 0xffff0000, v189
  v_fmac_f32 v26, v49, v52
  v_fmac_f32 v27, v49, v53
  v_lshlrev_b32 v52, 16, v190
  v_and_b32 v53, 0xffff0000, v190
  v_fmac_f32 v28, v49, v52
  v_fmac_f32 v29, v49, v53
  v_lshlrev_b32 v52, 16, v191
  v_and_b32 v53, 0xffff0000, v191
  v_fmac_f32 v30, v49, v52
  v_fmac_f32 v31, v49, v53
  buffer_load_dwordx4 v[160:163], v60, s[56:59], s73 offen offset:0 nt
  buffer_load_dwordx4 v[164:167], v60, s[56:59], s73 offen offset:256 nt
  buffer_load_dwordx4 v[168:171], v60, s[56:59], s73 offen offset:512 nt
  buffer_load_dwordx4 v[172:175], v60, s[56:59], s73 offen offset:768 nt
  buffer_load_dwordx4 v[176:179], v61, s[56:59], s73 offen offset:0 nt
  buffer_load_dwordx4 v[180:183], v61, s[56:59], s73 offen offset:256 nt
  buffer_load_dwordx4 v[184:187], v61, s[56:59], s73 offen offset:512 nt
  buffer_load_dwordx4 v[188:191], v61, s[56:59], s73 offen offset:768 nt
L_bloopX:
  s_cmp_eq_u32 s74, 1073741824
  s_cbranch_scc1 L_bdone
  s_mov_b64 exec, 1
  ds_add_rtn_u32 v42, v57, v56
  s_mov_b64 exec, -1
  s_waitcnt vmcnt(24)
  v_dot2_f32_bf16 v34, v64, v8, 0
  v_dot2_f32_bf16 v35, v68, v8, 0
  v_dot2_f32_bf16 v36, v72, v8, 0
  v_dot2_f32_bf16 v37, v76, v8, 0
  v_dot2_f32_bf16 v38, v80, v8, 0
  v_dot2_f32_bf16 v39, v84, v8, 0
  v_dot2_f32_bf16 v40, v88, v8, 0
  v_dot2_f32_bf16 v41, v92, v8, 0
  v_dot2_f32_bf16 v34, v65, v9, v34
  v_dot2_f32_bf16 v35, v69, v9, v35
  v_dot2_f32_bf16 v36, v73, v9, v36
  v_dot2_f32_bf16 v37, v77, v9, v37
  v_dot2_f32_bf16 v38, v81, v9, v38
  v_dot2_f32_bf16 v39, v85, v9, v39
  v_dot2_f32_bf16 v40, v89, v9, v40
  v_dot2_f32_bf16 v41, v93, v9, v41
  v_dot2_f32_bf16 v34, v66, v10, v34
  v_dot2_f32_bf16 v35, v70, v10, v35
  v_dot2_f32_bf16 v36, v74, v10, v36
  v_dot2_f32_bf16 v37, v78, v10, v37
  v_dot2_f32_bf16 v38, v82, v10, v38
  v_dot2_f32_bf16 v39, v86, v10, v39
  v_dot2_f32_bf16 v40, v90, v10, v40
  v_dot2_f32_bf16 v41, v94, v10, v41
  v_dot2_f32_bf16 v34, v67, v11, v34
  v_dot2_f32_bf16 v35, v71, v11, v35
  v_dot2_f32_bf16 v36, v75, v11, v36
  v_dot2_f32_bf16 v37, v79, v11, v37
  v_dot2_f32_bf16 v38, v83, v11, v38
  v_dot2_f32_bf16 v39, v87, v11, v39
  v_dot2_f32_bf16 v40, v91, v11, v40
  v_dot2_f32_bf16 v41, v95, v11, v41
  s_waitcnt lgkmcnt(0)
  v_readfirstlane_b32 s66, v42
  s_lshl_b32 s67, s66, 13
  s_cmp_lt_u32 s66, s70
  s_cselect_b32 s73, s67, 1073741824
  s_mov_b32 s74, s73
  buffer_load_dwordx4 v[64:67], v60, s[52:55], s73 offen offset:0 nt
  buffer_load_dwordx4 v[68:71], v60, s[52:55], s73 offen offset:256 nt
  buffer_load_dwordx4 v[72:75], v60, s[52:55], s73 offen offset:512 nt
  buffer_load_dwordx4 v[76:79], v60, s[52:55], s73 offen offset:768 nt
  buffer_load_dwordx4 v[80:83], v61, s[52:55], s73 offen offset:0 nt
  buffer_load_dwordx4 v[84:87], v61, s[52:55], s73 offen offset:256 nt
  buffer_load_dwordx4 v[88:91], v61, s[52:55], s73 offen offset:512 nt
  buffer_load_dwordx4 v[92:95], v61, s[52:55], s73 offen offset:768 nt
  v_add_f32_dpp v34, v34, v34 row_ror:8 row_mask:0xf bank_mask:0xf
  v_add_f32_dpp v35, v35, v35 row_ror:8 row_mask:0xf bank_mask:0xf
  v_add_f32_dpp v36, v36, v36 row_ror:8 row_mask:0xf bank_mask:0xf
  v_add_f32_dpp v37, v37, v37 row_ror:8 row_mask:0xf bank_mask:0xf
  v_add_f32_dpp v38, v38, v38 row_ror:8 row_mask:0xf bank_mask:0xf
  v_add_f32_dpp v39, v39, v39 row_ror:8 row_mask:0xf bank_mask:0xf
  v_add_f32_dpp v40, v40, v40 row_ror:8 row_mask:0xf bank_mask:0xf
  v_add_f32_dpp v41, v41, v41 row_ror:8 row_mask:0xf bank_mask:0xf
  v_add_f32_dpp v34, v34, v34 row_ror:4 row_mask:0xf bank_mask:0xf
  v_add_f32_dpp v35, v35, v35 row_ror:4 row_mask:0xf bank_mask:0xf
  v_add_f32_dpp v36, v36, v36 row_ror:4 row_mask:0xf bank_mask:0xf
  v_add_f32_dpp v37, v37, v37 row_ror:4 row_mask:0xf bank_mask:0xf
  v_add_f32_dpp v38, v38, v38 row_ror:4 row_mask:0xf bank_mask:0xf
  v_add_f32_dpp v39, v39, v39 row_ror:4 row_mask:0xf bank_mask:0xf
  v_add_f32_dpp v40, v40, v40 row_ror:4 row_mask:0xf bank_mask:0xf
  v_add_f32_dpp v41, v41, v41 row_ror:4 row_mask:0xf bank_mask:0xf
  v_add_f32_dpp v34, v34, v34 row_ror:2 row_mask:0xf bank_mask:0xf
  v_add_f32_dpp v35, v35, v35 row_ror:2 row_mask:0xf bank_mask:0xf
  v_add_f32_dpp v36, v36, v36 row_ror:2 row_mask:0xf bank_mask:0xf
  v_add_f32_dpp v37, v37, v37 row_ror:2 row_mask:0xf bank_mask:0xf
  v_add_f32_dpp v38, v38, v38 row_ror:2 row_mask:0xf bank_mask:0xf
  v_add_f32_dpp v39, v39, v39 row_ror:2 row_mask:0xf bank_mask:0xf
  v_add_f32_dpp v40, v40, v40 row_ror:2 row_mask:0xf bank_mask:0xf
  v_add_f32_dpp v41, v41, v41 row_ror:2 row_mask:0xf bank_mask:0xf
  v_add_f32_dpp v34, v34, v34 row_ror:1 row_mask:0xf bank_mask:0xf
  v_add_f32_dpp v35, v35, v35 row_ror:1 row_mask:0xf bank_mask:0xf
  v_add_f32_dpp v36, v36, v36 row_ror:1 row_mask:0xf bank_mask:0xf
  v_add_f32_dpp v37, v37, v37 row_ror:1 row_mask:0xf bank_mask:0xf
  v_add_f32_dpp v38, v38, v38 row_ror:1 row_mask:0xf bank_mask:0xf
  v_add_f32_dpp v39, v39, v39 row_ror:1 row_mask:0xf bank_mask:0xf
  v_add_f32_dpp v40, v40, v40 row_ror:1 row_mask:0xf bank_mask:0xf
  v_add_f32_dpp v41, v41, v41 row_ror:1 row_mask:0xf bank_mask:0xf
  v_cvt_pk_bf16_f32 v50, v34, v35
  v_lshlrev_b32 v42, 16, v50
  v_and_b32 v43, 0xffff0000, v50
  v_mul_f32 v42, s81, v42
  v_mul_f32 v43, s81, v43
  v_cvt_pk_bf16_f32 v50, v42, v43
  v_lshlrev_b32 v42, 16, v50
  v_and_b32 v43, 0xffff0000, v50
  v_cvt_pk_bf16_f32 v50, v36, v37
  v_lshlrev_b32 v44, 16, v50
  v_and_b32 v45, 0xffff0000, v50
  v_mul_f32 v44, s81, v44
  v_mul_f32 v45, s81, v45
  v_cvt_pk_bf16_f32 v50, v44, v45
  v_lshlrev_b32 v44, 16, v50
  v_and_b32 v45, 0xffff0000, v50
  v_cvt_pk_bf16_f32 v50, v38, v39
  v_lshlrev_b32 v46, 16, v50
  v_and_b32 v47, 0xffff0000, v50
  v_mul_f32 v46, s81, v46
  v_mul_f32 v47, s81, v47
  v_cvt_pk_bf16_f32 v50, v46, v47
  v_lshlrev_b32 v46, 16, v50
  v_and_b32 v47, 0xffff0000, v50
  v_cvt_pk_bf16_f32 v50, v40, v41
  v_lshlrev_b32 v48, 16, v50
  v_and_b32 v49, 0xffff0000, v50
  v_mul_f32 v48, s81, v48
  v_mul_f32 v49, s81, v49
  v_cvt_pk_bf16_f32 v50, v48, v49
  v_lshlrev_b32 v48, 16, v50
  v_and_b32 v49, 0xffff0000, v50
  v_max3_f32 v50, v42, v43, v44
  v_max3_f32 v51, v45, v46, v47
  v_max3_f32 v52, v48, v49, v32
  v_max3_f32 v50, v50, v51, v52
  v_sub_f32 v51, v32, v50
  v_mul_f32 v51, s80, v51
  v_exp_f32 v51, v51
  v_mov_b32 v32, v50
  v_sub_f32 v42, v42, v50
  v_sub_f32 v43, v43, v50
  v_sub_f32 v44, v44, v50
  v_sub_f32 v45, v45, v50
  v_sub_f32 v46, v46, v50
  v_sub_f32 v47, v47, v50
  v_sub_f32 v48, v48, v50
  v_sub_f32 v49, v49, v50
  v_mul_f32 v42, s80, v42
  v_mul_f32 v43, s80, v43
  v_mul_f32 v44, s80, v44
  v_mul_f32 v45, s80, v45
  v_mul_f32 v46, s80, v46
  v_mul_f32 v47, s80, v47
  v_mul_f32 v48, s80, v48
  v_mul_f32 v49, s80, v49
  v_exp_f32 v42, v42
  v_exp_f32 v43, v43
  v_exp_f32 v44, v44
  v_exp_f32 v45, v45
  v_exp_f32 v46, v46
  v_exp_f32 v47, v47
  v_exp_f32 v48, v48
  v_exp_f32 v49, v49
  v_mul_f32 v33, v33, v51
  v_mul_f32 v24, v24, v51
  v_mul_f32 v25, v25, v51
  v_mul_f32 v26, v26, v51
  v_mul_f32 v27, v27, v51
  v_mul_f32 v28, v28, v51
  v_mul_f32 v29, v29, v51
  v_mul_f32 v30, v30, v51
  v_mul_f32 v31, v31, v51
  v_add_f32 v52, v42, v43
  v_add_f32 v53, v44, v45
  v_add_f32 v54, v46, v47
  v_add_f32 v55, v48, v49
  v_add_f32 v52, v52, v53
  v_add_f32 v54, v54, v55
  v_add_f32 v52, v52, v54
  v_add_f32 v33, v33, v52
  s_waitcnt vmcnt(24)
  v_lshlrev_b32 v52, 16, v96
  v_and_b32 v53, 0xffff0000, v96
  v_fmac_f32 v24, v42, v52
  v_fmac_f32 v25, v42, v53
  v_lshlrev_b32 v52, 16, v97
  v_and_b32 v53, 0xffff0000, v97
  v_fmac_f32 v26, v42, v52
  v_fmac_f32 v27, v42, v53
  v_lshlrev_b32 v52, 16, v98
  v_and_b32 v53, 0xffff0000, v98
  v_fmac_f32 v28, v42, v52
  v_fmac_f32 v29, v42, v53
  v_lshlrev_b32 v52, 16, v99
  v_and_b32 v53, 0xffff0000, v99
  v_fmac_f32 v30, v42, v52
  v_fmac_f32 v31, v42, v53
  v_lshlrev_b32 v52, 16, v100
  v_and_b32 v53, 0xffff0000, v100
  v_fmac_f32 v24, v43, v52
  v_fmac_f32 v25, v43, v53
  v_lshlrev_b32 v52, 16, v101
  v_and_b32 v53, 0xffff0000, v101
  v_fmac_f32 v26, v43, v52
  v_fmac_f32 v27, v43, v53
  v_lshlrev_b32 v52, 16, v102
  v_and_b32 v53, 0xffff0000, v102
  v_fmac_f32 v28, v43, v52
  v_fmac_f32 v29, v43, v53
  v_lshlrev_b32 v52, 16, v103
  v_and_b32 v53, 0xffff0000, v103
  v_fmac_f32 v30, v43, v52
  v_fmac_f32 v31, v43, v53
  v_lshlrev_b32 v52, 16, v104
  v_and_b32 v53, 0xffff0000, v104
  v_fmac_f32 v24, v44, v52
  v_fmac_f32 v25, v44, v53
  v_lshlrev_b32 v52, 16, v105
  v_and_b32 v53, 0xffff0000, v105
  v_fmac_f32 v26, v44, v52
  v_fmac_f32 v27, v44, v53
  v_lshlrev_b32 v52, 16, v106
  v_and_b32 v53, 0xffff0000, v106
  v_fmac_f32 v28, v44, v52
  v_fmac_f32 v29, v44, v53
  v_lshlrev_b32 v52, 16, v107
  v_and_b32 v53, 0xffff0000, v107
  v_fmac_f32 v30, v44, v52
  v_fmac_f32 v31, v44, v53
  v_lshlrev_b32 v52, 16, v108
  v_and_b32 v53, 0xffff0000, v108
  v_fmac_f32 v24, v45, v52
  v_fmac_f32 v25, v45, v53
  v_lshlrev_b32 v52, 16, v109
  v_and_b32 v53, 0xffff0000, v109
  v_fmac_f32 v26, v45, v52
  v_fmac_f32 v27, v45, v53
  v_lshlrev_b32 v52, 16, v110
  v_and_b32 v53, 0xffff0000, v110
  v_fmac_f32 v28, v45, v52
  v_fmac_f32 v29, v45, v53
  v_lshlrev_b32 v52, 16, v111
  v_and_b32 v53, 0xffff0000, v111
  v_fmac_f32 v30, v45, v52
  v_fmac_f32 v31, v45, v53
  v_lshlrev_b32 v52, 16, v112
  v_and_b32 v53, 0xffff0000, v112
  v_fmac_f32 v24, v46, v52
  v_fmac_f32 v25, v46, v53
  v_lshlrev_b32 v52, 16, v113
  v_and_b32 v53, 0xffff0000, v113
  v_fmac_f32 v26, v46, v52
  v_fmac_f32 v27, v46, v53
  v_lshlrev_b32 v52, 16, v114
  v_and_b32 v53, 0xffff0000, v114
  v_fmac_f32 v28, v46, v52
  v_fmac_f32 v29, v46, v53
  v_lshlrev_b32 v52, 16, v115
  v_and_b32 v53, 0xffff0000, v115
  v_fmac_f32 v30, v46, v52
  v_fmac_f32 v31, v46, v53
  v_lshlrev_b32 v52, 16, v116
  v_and_b32 v53, 0xffff0000, v116
  v_fmac_f32 v24, v47, v52
  v_fmac_f32 v25, v47, v53
  v_lshlrev_b32 v52, 16, v117
  v_and_b32 v53, 0xffff0000, v117
  v_fmac_f32 v26, v47, v52
  v_fmac_f32 v27, v47, v53
  v_lshlrev_b32 v52, 16, v118
  v_and_b32 v53, 0xffff0000, v118
  v_fmac_f32 v28, v47, v52
  v_fmac_f32 v29, v47, v53
  v_lshlrev_b32 v52, 16, v119
  v_and_b32 v53, 0xffff0000, v119
  v_fmac_f32 v30, v47, v52
  v_fmac_f32 v31, v47, v53
  v_lshlrev_b32 v52, 16, v120
  v_and_b32 v53, 0xffff0000, v120
  v_fmac_f32 v24, v48, v52
  v_fmac_f32 v25, v48, v53
  v_lshlrev_b32 v52, 16, v121
  v_and_b32 v53, 0xffff0000, v121
  v_fmac_f32 v26, v48, v52
  v_fmac_f32 v27, v48, v53
  v_lshlrev_b32 v52, 16, v122
  v_and_b32 v53, 0xffff0000, v122
  v_fmac_f32 v28, v48, v52
  v_fmac_f32 v29, v48, v53
  v_lshlrev_b32 v52, 16, v123
  v_and_b32 v53, 0xffff0000, v123
  v_fmac_f32 v30, v48, v52
  v_fmac_f32 v31, v48, v53
  v_lshlrev_b32 v52, 16, v124
  v_and_b32 v53, 0xffff0000, v124
  v_fmac_f32 v24, v49, v52
  v_fmac_f32 v25, v49, v53
  v_lshlrev_b32 v52, 16, v125
  v_and_b32 v53, 0xffff0000, v125
  v_fmac_f32 v26, v49, v52
  v_fmac_f32 v27, v49, v53
  v_lshlrev_b32 v52, 16, v126
  v_and_b32 v53, 0xffff0000, v126
  v_fmac_f32 v28, v49, v52
  v_fmac_f32 v29, v49, v53
  v_lshlrev_b32 v52, 16, v127
  v_and_b32 v53, 0xffff0000, v127
  v_fmac_f32 v30, v49, v52
  v_fmac_f32 v31, v49, v53
  buffer_load_dwordx4 v[96:99], v60, s[56:59], s73 offen offset:0 nt
  buffer_load_dwordx4 v[100:103], v60, s[56:59], s73 offen offset:256 nt
  buffer_load_dwordx4 v[104:107], v60, s[56:59], s73 offen offset:512 nt
  buffer_load_dwordx4 v[108:111], v60, s[56:59], s73 offen offset:768 nt
  buffer_load_dwordx4 v[112:115], v61, s[56:59], s73 offen offset:0 nt
  buffer_load_dwordx4 v[116:119], v61, s[56:59], s73 offen offset:256 nt
  buffer_load_dwordx4 v[120:123], v61, s[56:59], s73 offen offset:512 nt
  buffer_load_dwordx4 v[124:127], v61, s[56:59], s73 offen offset:768 nt
  s_branch L_bloop
L_svc_entry:
  s_mov_b32 s73, s74
  buffer_load_dwordx4 v[64:67], v60, s[52:55], s73 offen offset:0 nt
  buffer_load_dwordx4 v[68:71], v60, s[52:55], s73 offen offset:256 nt
  buffer_load_dwordx4 v[72:75], v60, s[52:55], s73 offen offset:512 nt
  buffer_load_dwordx4 v[76:79], v60, s[52:55], s73 offen offset:768 nt
  buffer_load_dwordx4 v[80:83], v61, s[52:55], s73 offen offset:0 nt
  buffer_load_dwordx4 v[84:87], v61, s[52:55], s73 offen offset:256 nt
  buffer_load_dwordx4 v[88:91], v61, s[52:55], s73 offen offset:512 nt
  buffer_load_dwordx4 v[92:95], v61, s[52:55], s73 offen offset:768 nt
  buffer_load_dwordx4 v[96:99], v60, s[56:59], s73 offen offset:0 nt
  buffer_load_dwordx4 v[100:103], v60, s[56:59], s73 offen offset:256 nt
  buffer_load_dwordx4 v[104:107], v60, s[56:59], s73 offen offset:512 nt
  buffer_load_dwordx4 v[108:111], v60, s[56:59], s73 offen offset:768 nt
  buffer_load_dwordx4 v[112:115], v61, s[56:59], s73 offen offset:0 nt
  buffer_load_dwordx4 v[116:119], v61, s[56:59], s73 offen offset:256 nt
  buffer_load_dwordx4 v[120:123], v61, s[56:59], s73 offen offset:512 nt
  buffer_load_dwordx4 v[124:127], v61, s[56:59], s73 offen offset:768 nt
  s_mov_b32 s73, s75
  buffer_load_dwordx4 v[128:131], v60, s[52:55], s73 offen offset:0 nt
  buffer_load_dwordx4 v[132:135], v60, s[52:55], s73 offen offset:256 nt
  buffer_load_dwordx4 v[136:139], v60, s[52:55], s73 offen offset:512 nt
  buffer_load_dwordx4 v[140:143], v60, s[52:55], s73 offen offset:768 nt
  buffer_load_dwordx4 v[144:147], v61, s[52:55], s73 offen offset:0 nt
  buffer_load_dwordx4 v[148:151], v61, s[52:55], s73 offen offset:256 nt
  buffer_load_dwordx4 v[152:155], v61, s[52:55], s73 offen offset:512 nt
  buffer_load_dwordx4 v[156:159], v61, s[52:55], s73 offen offset:768 nt
  buffer_load_dwordx4 v[160:163], v60, s[56:59], s73 offen offset:0 nt
  buffer_load_dwordx4 v[164:167], v60, s[56:59], s73 offen offset:256 nt
  buffer_load_dwordx4 v[168:171], v60, s[56:59], s73 offen offset:512 nt
  buffer_load_dwordx4 v[172:175], v60, s[56:59], s73 offen offset:768 nt
  buffer_load_dwordx4 v[176:179], v61, s[56:59], s73 offen offset:0 nt
  buffer_load_dwordx4 v[180:183], v61, s[56:59], s73 offen offset:256 nt
  buffer_load_dwordx4 v[184:187], v61, s[56:59], s73 offen offset:512 nt
  buffer_load_dwordx4 v[188:191], v61, s[56:59], s73 offen offset:768 nt
  s_waitcnt vmcnt(32) lgkmcnt(0)
  v_mov_b32 v8, v224
  v_mov_b32 v9, v225
  v_mov_b32 v10, v226
  v_mov_b32 v11, v227
  s_barrier
  v_lshrrev_b32 v44, 2, v3
  v_lshl_add_u32 v44, v2, 3, v44
  v_mul_u32_u24 v44, 1056, v44
  v_and_b32 v45, 3, v1
  v_lshl_add_u32 v44, v45, 3, v44
  s_lshl_b32 s66, s48, 7
  v_add_u32 v44, s66, v44
  v_add_u32 v45, 67584, v44
  ds_read_b64_tr_b16 v[192:193], v44 offset:0
  ds_read_b64_tr_b16 v[194:195], v44 offset:4224
  ds_read_b64_tr_b16 v[196:197], v44 offset:32
  ds_read_b64_tr_b16 v[198:199], v44 offset:4256
  ds_read_b64_tr_b16 v[200:201], v44 offset:64
  ds_read_b64_tr_b16 v[202:203], v44 offset:4288
  ds_read_b64_tr_b16 v[204:205], v44 offset:96
  ds_read_b64_tr_b16 v[206:207], v44 offset:4320
  ds_read_b64_tr_b16 v[208:209], v44 offset:33792
  ds_read_b64_tr_b16 v[210:211], v44 offset:38016
  ds_read_b64_tr_b16 v[212:213], v44 offset:33824
  ds_read_b64_tr_b16 v[214:215], v44 offset:38048
  ds_read_b64_tr_b16 v[216:217], v44 offset:33856
  ds_read_b64_tr_b16 v[218:219], v44 offset:38080
  ds_read_b64_tr_b16 v[220:221], v44 offset:33888
  ds_read_b64_tr_b16 v[222:223], v44 offset:38112
  ds_read_b64_tr_b16 v[224:225], v45 offset:0
  ds_read_b64_tr_b16 v[226:227], v45 offset:4224
  ds_read_b64_tr_b16 v[228:229], v45 offset:32
  ds_read_b64_tr_b16 v[230:231], v45 offset:4256
  ds_read_b64_tr_b16 v[232:233], v45 offset:64
  ds_read_b64_tr_b16 v[234:235], v45 offset:4288
  ds_read_b64_tr_b16 v[236:237], v45 offset:96
  ds_read_b64_tr_b16 v[238:239], v45 offset:4320
  ds_read_b64_tr_b16 v[240:241], v45 offset:33792
  ds_read_b64_tr_b16 v[242:243], v45 offset:38016
  ds_read_b64_tr_b16 v[244:245], v45 offset:33824
  ds_read_b64_tr_b16 v[246:247], v45 offset:38048
  ds_read_b64_tr_b16 v[248:249], v45 offset:33856
  ds_read_b64_tr_b16 v[250:251], v45 offset:38080
  ds_read_b64_tr_b16 v[252:253], v45 offset:33888
  ds_read_b64_tr_b16 v[254:255], v45 offset:38112
  s_waitcnt lgkmcnt(0)
  s_mov_b32 s76, 1
  s_cmp_eq_u32 s48, 0
  s_cbranch_scc0 L_nca_21
  s_waitcnt vmcnt(0)
  s_add_u32 s90, s42, 987136
  s_addc_u32 s91, s43, 0
  v_lshlrev_b32 v42, 7, v1
  v_mov_b32 v43, 1
  s_mov_b64 exec, 0xffff
  global_atomic_add v42, v43, s[90:91] sc1
  s_mov_b64 exec, -1
  s_waitcnt vmcnt(0)
L_nca_21:
  s_branch L_bloopX
L_bdone:
  s_waitcnt vmcnt(0)
  global_load_dword v62, v4, s[40:41] sc1
  s_cmp_eq_u32 s76, 1
  s_cbranch_scc1 L_trd_22
  s_barrier
  v_lshrrev_b32 v44, 2, v3
  v_lshl_add_u32 v44, v2, 3, v44
  v_mul_u32_u24 v44, 1056, v44
  v_and_b32 v45, 3, v1
  v_lshl_add_u32 v44, v45, 3, v44
  s_lshl_b32 s66, s48, 7
  v_add_u32 v44, s66, v44
  v_add_u32 v45, 67584, v44
  ds_read_b64_tr_b16 v[192:193], v44 offset:0
  ds_read_b64_tr_b16 v[194:195], v44 offset:4224
  ds_read_b64_tr_b16 v[196:197], v44 offset:32
  ds_read_b64_tr_b16 v[198:199], v44 offset:4256
  ds_read_b64_tr_b16 v[200:201], v44 offset:64
  ds_read_b64_tr_b16 v[202:203], v44 offset:4288
  ds_read_b64_tr_b16 v[204:205], v44 offset:96
  ds_read_b64_tr_b16 v[206:207], v44 offset:4320
  ds_read_b64_tr_b16 v[208:209], v44 offset:33792
  ds_read_b64_tr_b16 v[210:211], v44 offset:38016
  ds_read_b64_tr_b16 v[212:213], v44 offset:33824
  ds_read_b64_tr_b16 v[214:215], v44 offset:38048
  ds_read_b64_tr_b16 v[216:217], v44 offset:33856
  ds_read_b64_tr_b16 v[218:219], v44 offset:38080
  ds_read_b64_tr_b16 v[220:221], v44 offset:33888
  ds_read_b64_tr_b16 v[222:223], v44 offset:38112
  ds_read_b64_tr_b16 v[224:225], v45 offset:0
  ds_read_b64_tr_b16 v[226:227], v45 offset:4224
  ds_read_b64_tr_b16 v[228:229], v45 offset:32
  ds_read_b64_tr_b16 v[230:231], v45 offset:4256
  ds_read_b64_tr_b16 v[232:233], v45 offset:64
  ds_read_b64_tr_b16 v[234:235], v45 offset:4288
  ds_read_b64_tr_b16 v[236:237], v45 offset:96
  ds_read_b64_tr_b16 v[238:239], v45 offset:4320
  ds_read_b64_tr_b16 v[240:241], v45 offset:33792
  ds_read_b64_tr_b16 v[242:243], v45 offset:38016
  ds_read_b64_tr_b16 v[244:245], v45 offset:33824
  ds_read_b64_tr_b16 v[246:247], v45 offset:38048
  ds_read_b64_tr_b16 v[248:249], v45 offset:33856
  ds_read_b64_tr_b16 v[250:251], v45 offset:38080
  ds_read_b64_tr_b16 v[252:253], v45 offset:33888
  ds_read_b64_tr_b16 v[254:255], v45 offset:38112
  s_waitcnt lgkmcnt(0)
  s_mov_b32 s76, 1
L_trd_22:
  s_lshl_b32 s66, s48, 2
  v_add_u32 v42, s66, v2
  v_lshlrev_b32 v43, 3, v42
  v_add_u32 v43, 148224, v43
  v_mul_u32_u24 v46, 272, v42
  v_lshl_add_u32 v46, v3, 4, v46
  v_add_u32 v46, 139520, v46
  v_cvt_pk_bf16_f32 v52, v24, v25
  v_cvt_pk_bf16_f32 v53, v26, v27
  v_cvt_pk_bf16_f32 v54, v28, v29
  v_cvt_pk_bf16_f32 v55, v30, v31
  ds_write_b64 v43, v[32:33]
  ds_write_b128 v46, v[52:55]
  v_mul_u32_u24 v47, 272, v3
  v_lshl_add_u32 v47, v2, 4, v47
  v_add_u32 v47, 139520, v47
  v_mov_b32 v48, 148224
  v_lshlrev_b32 v49, 5, v2
  v_add_u32 v49, 148224, v49
  s_waitcnt lgkmcnt(0)
  s_barrier
  ds_read_b128 v[64:67], v47 offset:0
  ds_read_b128 v[68:71], v47 offset:64
  ds_read_b128 v[72:75], v47 offset:128
  ds_read_b128 v[76:79], v47 offset:192
  ds_read_b128 v[80:83], v47 offset:4352
  ds_read_b128 v[84:87], v47 offset:4416
  ds_read_b128 v[88:91], v47 offset:4480
  ds_read_b128 v[92:95], v47 offset:4544
  ds_read_b128 v[96:99], v48 offset:0
  ds_read_b128 v[100:103], v48 offset:16
  ds_read_b128 v[104:107], v48 offset:32
  ds_read_b128 v[108:111], v48 offset:48
  ds_read_b128 v[112:115], v48 offset:64
  ds_read_b128 v[116:119], v48 offset:80
  ds_read_b128 v[120:123], v48 offset:96
  ds_read_b128 v[124:127], v48 offset:112
  ds_read_b128 v[128:131], v48 offset:128
  ds_read_b128 v[132:135], v48 offset:144
  ds_read_b128 v[136:139], v48 offset:160
  ds_read_b128 v[140:143], v48 offset:176
  ds_read_b128 v[144:147], v48 offset:192
  ds_read_b128 v[148:151], v48 offset:208
  ds_read_b128 v[152:155], v48 offset:224
  ds_read_b128 v[156:159], v48 offset:240
  ds_read_b128 v[160:163], v49 offset:0
  ds_read_b128 v[164:167], v49 offset:16
  ds_read_b128 v[168:171], v49 offset:128
  ds_read_b128 v[172:175], v49 offset:144
  s_waitcnt lgkmcnt(15)
  v_mfma_f32_16x16x32_bf16 v[8:11], v[64:67], v[192:195], 0
  v_mfma_f32_16x16x32_bf16 v[12:15], v[64:67], v[196:199], 0
  v_mfma_f32_16x16x32_bf16 v[16:19], v[64:67], v[200:203], 0
  v_mfma_f32_16x16x32_bf16 v[20:23], v[64:67], v[204:207], 0
  v_mfma_f32_16x16x32_bf16 v[24:27], v[80:83], v[192:195], 0
  v_mfma_f32_16x16x32_bf16 v[28:31], v[80:83], v[196:199], 0
  v_mfma_f32_16x16x32_bf16 v[32:35], v[80:83], v[200:203], 0
  v_mfma_f32_16x16x32_bf16 v[36:39], v[80:83], v[204:207], 0
  v_mfma_f32_16x16x32_bf16 v[8:11], v[68:71], v[208:211], v[8:11]
  v_mfma_f32_16x16x32_bf16 v[12:15], v[68:71], v[212:215], v[12:15]
  v_mfma_f32_16x16x32_bf16 v[16:19], v[68:71], v[216:219], v[16:19]
  v_mfma_f32_16x16x32_bf16 v[20:23], v[68:71], v[220:223], v[20:23]
  v_mfma_f32_16x16x32_bf16 v[24:27], v[84:87], v[208:211], v[24:27]
  v_mfma_f32_16x16x32_bf16 v[28:31], v[84:87], v[212:215], v[28:31]
  v_mfma_f32_16x16x32_bf16 v[32:35], v[84:87], v[216:219], v[32:35]
  v_mfma_f32_16x16x32_bf16 v[36:39], v[84:87], v[220:223], v[36:39]
  v_mfma_f32_16x16x32_bf16 v[8:11], v[72:75], v[224:227], v[8:11]
  v_mfma_f32_16x16x32_bf16 v[12:15], v[72:75], v[228:231], v[12:15]
  v_mfma_f32_16x16x32_bf16 v[16:19], v[72:75], v[232:235], v[16:19]
  v_mfma_f32_16x16x32_bf16 v[20:23], v[72:75], v[236:239], v[20:23]
  v_mfma_f32_16x16x32_bf16 v[24:27], v[88:91], v[224:227], v[24:27]
  v_mfma_f32_16x16x32_bf16 v[28:31], v[88:91], v[228:231], v[28:31]
  v_mfma_f32_16x16x32_bf16 v[32:35], v[88:91], v[232:235], v[32:35]
  v_mfma_f32_16x16x32_bf16 v[36:39], v[88:91], v[236:239], v[36:39]
  v_mfma_f32_16x16x32_bf16 v[8:11], v[76:79], v[240:243], v[8:11]
  v_mfma_f32_16x16x32_bf16 v[12:15], v[76:79], v[244:247], v[12:15]
  v_mfma_f32_16x16x32_bf16 v[16:19], v[76:79], v[248:251], v[16:19]
  v_mfma_f32_16x16x32_bf16 v[20:23], v[76:79], v[252:255], v[20:23]
  v_mfma_f32_16x16x32_bf16 v[24:27], v[92:95], v[240:243], v[24:27]
  v_mfma_f32_16x16x32_bf16 v[28:31], v[92:95], v[244:247], v[28:31]
  v_mfma_f32_16x16x32_bf16 v[32:35], v[92:95], v[248:251], v[32:35]
  v_mfma_f32_16x16x32_bf16 v[36:39], v[92:95], v[252:255], v[36:39]
  s_waitcnt lgkmcnt(0)
  v_max3_f32 v96, v96, v98, v100
  v_max3_f32 v102, v102, v104, v106
  v_max3_f32 v108, v108, v110, v112
  v_max3_f32 v114, v114, v116, v118
  v_max3_f32 v120, v120, v122, v124
  v_max3_f32 v126, v126, v128, v130
  v_max3_f32 v132, v132, v134, v136
  v_max3_f32 v138, v138, v140, v142
  v_max3_f32 v144, v144, v146, v148
  v_max3_f32 v150, v150, v152, v154
  v_max3_f32 v96, v96, v102, v108
  v_max3_f32 v114, v114, v120, v126
  v_max3_f32 v132, v132, v138, v144
  v_max3_f32 v150, v150, v156, v158
  v_max3_f32 v50, v96, v114, v132
  v_max_f32 v50, v50, v150
  v_sub_f32 v160, v160, v50
  v_mul_f32 v160, s80, v160
  v_sub_f32 v162, v162, v50
  v_mul_f32 v162, s80, v162
  v_sub_f32 v164, v164, v50
  v_mul_f32 v164, s80, v164
  v_sub_f32 v166, v166, v50
  v_mul_f32 v166, s80, v166
  v_sub_f32 v168, v168, v50
  v_mul_f32 v168, s80, v168
  v_sub_f32 v170, v170, v50
  v_mul_f32 v170, s80, v170
  v_sub_f32 v172, v172, v50
  v_mul_f32 v172, s80, v172
  v_sub_f32 v174, v174, v50
  v_mul_f32 v174, s80, v174
  v_exp_f32 v160, v160
  v_exp_f32 v162, v162
  v_exp_f32 v164, v164
  v_exp_f32 v166, v166
  v_exp_f32 v168, v168
  v_exp_f32 v170, v170
  v_exp_f32 v172, v172
  v_exp_f32 v174, v174
  s_nop 0
  v_mul_f32 v44, v160, v161
  v_fmac_f32 v44, v162, v163
  v_fmac_f32 v44, v164, v165
  v_fmac_f32 v44, v166, v167
  v_fmac_f32 v44, v168, v169
  v_fmac_f32 v44, v170, v171
  v_fmac_f32 v44, v172, v173
  v_fmac_f32 v44, v174, v175
  v_mul_f32 v40, v160, v8
  v_fmac_f32 v40, v162, v9
  v_fmac_f32 v40, v164, v10
  v_fmac_f32 v40, v166, v11
  v_fmac_f32 v40, v168, v24
  v_fmac_f32 v40, v170, v25
  v_fmac_f32 v40, v172, v26
  v_fmac_f32 v40, v174, v27
  v_mul_f32 v41, v160, v12
  v_fmac_f32 v41, v162, v13
  v_fmac_f32 v41, v164, v14
  v_fmac_f32 v41, v166, v15
  v_fmac_f32 v41, v168, v28
  v_fmac_f32 v41, v170, v29
  v_fmac_f32 v41, v172, v30
  v_fmac_f32 v41, v174, v31
  v_mul_f32 v42, v160, v16
  v_fmac_f32 v42, v162, v17
  v_fmac_f32 v42, v164, v18
  v_fmac_f32 v42, v166, v19
  v_fmac_f32 v42, v168, v32
  v_fmac_f32 v42, v170, v33
  v_fmac_f32 v42, v172, v34
  v_fmac_f32 v42, v174, v35
  v_mul_f32 v43, v160, v20
  v_fmac_f32 v43, v162, v21
  v_fmac_f32 v43, v164, v22
  v_fmac_f32 v43, v166, v23
  v_fmac_f32 v43, v168, v36
  v_fmac_f32 v43, v170, v37
  v_fmac_f32 v43, v172, v38
  v_fmac_f32 v43, v174, v39
  ds_swizzle_b32 v52, v40 offset:0x401f
  ds_swizzle_b32 v53, v41 offset:0x401f
  ds_swizzle_b32 v54, v42 offset:0x401f
  ds_swizzle_b32 v55, v43 offset:0x401f
  ds_swizzle_b32 v56, v44 offset:0x401f
  s_waitcnt lgkmcnt(0)
  v_add_f32 v40, v40, v52
  v_add_f32 v41, v41, v53
  v_add_f32 v42, v42, v54
  v_add_f32 v43, v43, v55
  v_add_f32 v44, v44, v56
  v_mov_b32 v52, v40
  v_mov_b32 v53, v40
  s_nop 1
  v_permlane32_swap_b32 v52, v53
  s_nop 1
  v_add_f32 v40, v52, v53
  v_mov_b32 v52, v41
  v_mov_b32 v53, v41
  s_nop 1
  v_permlane32_swap_b32 v52, v53
  s_nop 1
  v_add_f32 v41, v52, v53
  v_mov_b32 v52, v42
  v_mov_b32 v53, v42
  s_nop 1
  v_permlane32_swap_b32 v52, v53
  s_nop 1
  v_add_f32 v42, v52, v53
  v_mov_b32 v52, v43
  v_mov_b32 v53, v43
  s_nop 1
  v_permlane32_swap_b32 v52, v53
  s_nop 1
  v_add_f32 v43, v52, v53
  v_mov_b32 v52, v44
  v_mov_b32 v53, v44
  s_nop 1
  v_permlane32_swap_b32 v52, v53
  s_nop 1
  v_add_f32 v44, v52, v53
  v_mov_b32 v16, v50
  v_mov_b32 v17, v44
  v_cmp_eq_u32 vcc, 1, v2
  s_nop 1
  v_cndmask_b32 v40, v40, v41, vcc
  v_cmp_eq_u32 vcc, 2, v2
  s_nop 1
  v_cndmask_b32 v40, v40, v42, vcc
  v_cmp_eq_u32 vcc, 3, v2
  s_nop 1
  v_cndmask_b32 v40, v40, v43, vcc
  s_lshl_b32 s66, s46, 7
  s_lshl_b32 s67, s44, 2
  s_add_u32 s66, s66, s67
  s_add_u32 s66, s66, s47
  s_lshl_b32 s67, s66, 11
  s_lshl_b32 s68, s48, 8
  s_add_u32 s67, s67, s68
  s_add_u32 s92, s42, s67
  s_addc_u32 s93, s43, 0
  s_add_u32 s92, s92, 1048576
  s_addc_u32 s93, s93, 0
  s_lshl_b32 s67, s66, 3
  s_add_u32 s94, s42, s67
  s_addc_u32 s95, s43, 0
  s_add_u32 s94, s94, 917504
  s_addc_u32 s95, s95, 0
  v_lshlrev_b32 v12, 2, v1
  global_store_dword v12, v40, s[92:93] sc1
  s_mov_b64 exec, 1
  global_store_dwordx2 v4, v[16:17], s[94:95] sc1
  s_mov_b64 exec, -1
  s_waitcnt vmcnt(0)
  s_barrier
  s_cmp_eq_u32 s48, 0
  s_cbranch_scc0 L_sk_23
  v_readfirstlane_b32 s66, v62
  s_cmp_ge_u32 s66, 64
  s_cbranch_scc1 L_ok_24
  s_mov_b32 s79, 0
L_poll_25:
  global_load_dword v12, v4, s[40:41] offset:0 sc1
  s_waitcnt vmcnt(0)
  v_readfirstlane_b32 s66, v12
  s_cmp_ge_u32 s66, 64
  s_cbranch_scc1 L_polld_26
  s_sleep 1
  s_add_u32 s79, s79, 1
  s_cmp_lt_u32 s79, 0x20000
  s_cbranch_scc1 L_poll_25
L_polld_26:
L_ok_24:
  s_lshl_b32 s77, s46, 11
  s_add_u32 s94, s42, s77
  s_addc_u32 s95, s43, 0
  s_add_u32 s94, s94, 983040
  s_addc_u32 s95, s95, 0
  v_lshlrev_b32 v12, 7, v1
  v_mov_b32 v13, 1
  s_mov_b64 exec, 0xffff
  global_atomic_add v12, v13, s[94:95] sc1
  s_mov_b64 exec, -1
L_sk_23:
  s_sub_u32 s83, s2, 64
  s_cmp_lt_u32 s83, 64
  s_cbranch_scc1 L_bfinal
L_end:
  s_endpgm
.section .rodata,"a"
.p2align 6
.amdhsa_kernel concat_heads__compressed_kv_cla__mha_block_cached__decode_kernel
  .amdhsa_next_free_vgpr 256
  .amdhsa_next_free_sgpr 102
  .amdhsa_accum_offset 256
  .amdhsa_group_segment_fixed_size 0
  .amdhsa_kernarg_size 112
  .amdhsa_user_sgpr_count 2
  .amdhsa_user_sgpr_kernarg_segment_ptr 1
  .amdhsa_system_sgpr_workgroup_id_x 1
.end_amdhsa_kernel
```
